```python
import torch

def _softmax(x, axis=-1):
    return torch.softmax(x, dim=axis)
def _gelu(x):
    return torch.nn.functional.gelu(x, approximate="tanh")
def _silu(x):
    return torch.nn.functional.silu(x)
def _sigmoid(x):
    return torch.sigmoid(x)
def _layernorm(x, axis=-1, eps=1e-5):
    m = x.mean(dim=axis, keepdim=True)
    v = x.var(dim=axis, keepdim=True, unbiased=False)
    return (x - m) / torch.sqrt(v + eps)
def _scatter_add(tgt, idx, src, axis=0):
    return tgt.clone().index_add_(axis, idx, src)
def _segment_sum(src, seg, n):
    out = torch.zeros((n,) + src.shape[1:], dtype=src.dtype)
    return out.index_add_(0, seg, src)
def _pad(x, pw):
    flat = tuple(v for pair in reversed(pw) for v in pair)
    return torch.nn.functional.pad(x, flat)

kernel_name = 'recurrent_scan__linear_kernel_hedgehog__glu_gated_geglu__prompt'

def setup_inputs():

    _w = (lambda a: (lambda t: t.to(torch.bfloat16) if t.is_floating_point() else t)(torch.as_tensor(a)))
    def _A_setup():
        B, S, D, H = 1, 2048, 512, 32
        Dh = D // H
        return {
            "x": _w((lambda *s: torch.randn(*s, dtype=torch.bfloat16) * 0.05)(B, S, D)),
            "wqkv": _w((lambda *s: torch.randn(*s, dtype=torch.bfloat16) * 0.8)(D, 3 * D)),
            "w_phi": _w((lambda *s: torch.randn(*s, dtype=torch.bfloat16) * 0.8)(H, Dh, Dh) * (Dh ** -0.5)),
            "wo": _w((lambda *s: torch.randn(*s, dtype=torch.bfloat16) * 0.8)(D, D)),
        }
    _A_in = _A_setup()

    def _B_setup():
        B, S, Dm, Df = 1, 2048, 512, 1792
        return {
            "x": _w((lambda *s: torch.randn(*s, dtype=torch.bfloat16) * 0.05)(B, S, Dm)),
            "w_gate": _w((lambda *s: torch.randn(*s, dtype=torch.bfloat16) * 0.2)(Dm, Df) * (Dm ** -0.5)),
            "w_up": _w((lambda *s: torch.randn(*s, dtype=torch.bfloat16) * 0.2)(Dm, Df) * (Dm ** -0.5)),
            "w_down": _w((lambda *s: torch.randn(*s, dtype=torch.bfloat16) * 0.2)(Df, Dm) * (Df ** -0.5)),
        }
    _B_in = _B_setup()

    return {
        "A_x": _A_in["x"],
        "A_wqkv": _A_in["wqkv"],
        "A_w_phi": _A_in["w_phi"],
        "A_wo": _A_in["wo"],
        "B_x": _B_in["x"],
        "B_w_gate": _B_in["w_gate"],
        "B_w_up": _B_in["w_up"],
        "B_w_down": _B_in["w_down"],
    }

def reference(A_x, A_wqkv, A_w_phi, A_wo, B_x, B_w_gate, B_w_up, B_w_down):
    def _A_ref(x, wqkv, w_phi, wo):
        B, S, D = x.shape
        H = 32; Dh = D // H
        qkv = (lambda x, *d: x.permute(*d))((x @ wqkv).reshape(B, S, 3, H, Dh), 2, 0, 3, 1, 4)
        q, k, v = qkv[0], qkv[1], qkv[2]
        pq = torch.einsum("bhsd,hdf->bhsf", q, w_phi)
        pk = torch.einsum("bhsd,hdf->bhsf", k, w_phi)
        phi_q = torch.concatenate([_softmax(pq, axis=-1), _softmax(-pq, axis=-1)], axis=-1)
        phi_k = torch.concatenate([_softmax(pk, axis=-1), _softmax(-pk, axis=-1)], axis=-1)
        kv = torch.einsum("bhsf,bhsd->bhfd", phi_k, v)
        z  = torch.einsum("bhsf->bhf", phi_k)
        num = torch.einsum("bhqf,bhfd->bhqd", phi_q, kv)
        den = torch.einsum("bhqf,bhf->bhq", phi_q, z)[..., None] + 1e-6
        o = num / den
        return (lambda x, *d: x.permute(*d))(o, 0, 2, 1, 3).reshape(B, S, D) @ wo

    def _B_ref(x, w_gate, w_up, w_down):
        g = torch.einsum("bsd,df->bsf", x, w_gate)
        u = torch.einsum("bsd,df->bsf", x, w_up)
        h = _gelu(g) * u
        return torch.einsum("bsf,fd->bsd", h, w_down)

    x = A_x
    xn = _layernorm(x, axis=-1)
    s = _A_ref(xn, A_wqkv, A_w_phi, A_wo)
    g = _silu(_B_ref(xn, B_w_gate, B_w_up, B_w_down))
    return x + s * g
```

```asm
; @launch grid=(256,1,1) block=(512,1,1) lds=163840
.amdgcn_target "amdgcn-amd-amdhsa--gfx950"
.text
.globl recurrent_scan__linear_kernel_hedgehog__glu_gated_geglu__prompt_kernel
.p2align 8
.type recurrent_scan__linear_kernel_hedgehog__glu_gated_geglu__prompt_kernel,@function
recurrent_scan__linear_kernel_hedgehog__glu_gated_geglu__prompt_kernel:
    s_cmp_ge_u32 s2, 256
    s_cbranch_scc1 L_done
    s_load_dwordx16 s[64:79], s[0:1], 0
    s_load_dwordx4 s[80:83], s[0:1], 64
    s_load_dwordx2 s[84:85], s[0:1], 80
    s_setprio 3
    s_getpc_b64 s[44:45]
L_pc:
    v_lshrrev_b32 v2, 6, v0
    v_and_b32 v1, 63, v0
    v_lshlrev_b32 v232, 4, v1
    v_lshlrev_b32 v219, 7, v1
    v_readfirstlane_b32 s50, v2
    s_and_b32 s3, s2, 7
    s_lshr_b32 s61, s2, 3
    s_and_b32 s48, s3, 1
    s_lshl_b32 s48, s48, 2
    s_and_b32 s62, s61, 3
    s_add_u32 s48, s48, s62
    s_lshr_b32 s40, s3, 1
    s_lshr_b32 s41, s2, 5
    s_lshl_b32 s49, s40, 3
    s_add_u32 s49, s49, s41
    s_mov_b32 s6, 262144
    s_mov_b32 s7, 0x20000
    s_lshl_b32 s42, s49, 3
    s_add_u32 s42, s42, s50
    s_xor_b32 s63, s61, s41
    s_and_b32 s63, s63, 0
    s_cmp_eq_u32 s50, 0
    s_cselect_b32 s62, 18, 21
    s_cmp_eq_u32 s50, 3
    s_cselect_b32 s62, (L_end-L_pc)/4096+1, s62
    s_cselect_b32 s61, s61, s2
    s_cmp_gt_u32 s50, 3
    s_cselect_b32 s62, 0, s62
    s_mul_i32 s61, s61, s62
    s_lshl_b32 s61, s61, 7
    s_bfm_b64 s[46:47], s62, 0
    s_lshl_b32 s3, s48, 18
    s_lshl_b32 s43, s42, 10
    v_lshrrev_b32 v2, 3, v1
    v_and_b32 v3, 7, v1
    v_lshrrev_b32 v4, 4, v1
    v_xor_b32 v5, v3, v4
    v_lshlrev_b32 v5, 4, v5
    s_lshl_b32 s62, s50, 5
    v_add_u32 v6, s62, v2
    v_lshl_add_u32 v200, v6, 10, v5
    v_add_u32 v15, s61, v219
    v_min_u32 v13, L_end-L_pc-4, v15
    s_cmp_eq_u32 s50, 3
    s_cselect_b64 vcc, -1, 0
    v_cndmask_b32 v15, v15, v13, vcc
    v_xor_b32 v201, 64, v200
    v_add_u32 v202, 14336, v200
    v_add_u32 v203, 21504, v201
    v_add_u32 v201, 7168, v201
    s_lshl_b32 s55, s50, 12
    s_mov_b32 m0, s55
    s_waitcnt lgkmcnt(0)
    s_lshl_b32 s0, s63, 7
    s_add_u32 s4, s64, s3
    s_addc_u32 s5, s65, 0
    s_and_b32 s5, s5, 0xffff
    s_cmp_eq_u32 s50, 0
    s_cselect_b32 s44, s66, s44
    s_cselect_b32 s45, s67, s45
    s_cmp_eq_u32 s50, 1
    s_cselect_b32 s44, s74, s44
    s_cselect_b32 s45, s75, s45
    s_cmp_eq_u32 s50, 2
    s_cselect_b32 s44, s76, s44
    s_cselect_b32 s45, s77, s45
    s_mov_b64 exec, s[46:47]
    global_load_dword v255, v15, s[44:45]
    s_mov_b64 exec, -1
    buffer_load_dwordx4 v[220:223], v232, s[4:7], s43 offen
    s_setprio 2
    buffer_load_dwordx4 v200, s[4:7], s0 offen offset:0 lds
    s_mul_i32 s61, s40, 7
    s_add_u32 s61, s61, s41
    s_lshl_b32 s58, s61, 7
    s_lshl_b32 s59, s40, 8
    s_movk_i32 s54, 3584
    s_cmp_eq_u32 s41, 7
    s_cselect_b32 s51, 1, 0
    s_cselect_b32 s54, 3072, s54
    s_cselect_b32 s58, s59, s58
    s_cselect_b32 s8, s66, s74
    s_cselect_b32 s9, s67, s75
    s_cselect_b32 s12, s66, s76
    s_cselect_b32 s13, s67, s77
    buffer_load_dwordx4 v201, s[4:7], s0 offen offset:1024 lds
    s_lshl_b32 s59, s51, 7
    s_add_u32 s59, s59, s58
    s_lshl_b32 s3, s50, 3
    v_add_u32 v6, s3, v2
    v_mul_lo_u32 v6, v6, s54
    v_and_b32 v7, 1, v4
    v_lshlrev_b32 v5, 2, v7
    v_xor_b32 v14, v5, v3
    v_lshl_add_u32 v204, v14, 4, v6
    v_bfe_u32 v6, v1, 2, 3
    v_add_u32 v6, s3, v6
    v_mul_u32_u24 v6, 3072, v6
    v_and_b32 v5, 1, v1
    v_lshl_add_u32 v6, v5, 4, v6
    v_bfe_u32 v5, v1, 1, 1
    v_lshl_add_u32 v205, v5, 10, v6
    buffer_load_dwordx4 v202, s[4:7], s0 offen offset:2048 lds
    s_lshl_b32 s54, s54, 6
    s_mul_i32 s56, s50, 2560
    s_add_u32 s56, s56, 98304
    s_mov_b32 s11, 0x20000
    s_mov_b32 s15, 0x20000
    s_mov_b32 s19, 0x20000
    s_lshl_b32 s62, s54, 3
    s_sub_u32 s10, s62, s58
    s_sub_u32 s59, s59, 1024
    s_sub_u32 s14, s62, s59
    s_lshl_b32 s62, s49, 5
    s_sub_u32 s62, s62, 1024
    s_sub_u32 s18, 1572864, s62
    s_lshr_b32 s54, s54, 7
    buffer_load_dwordx4 v203, s[4:7], s0 offen offset:3072 lds
    s_add_u32 s8, s8, s58
    s_addc_u32 s9, s9, 0
    s_and_b32 s9, s9, 0xffff
    s_ashr_i32 s3, s59, 31
    s_add_u32 s12, s12, s59
    s_addc_u32 s13, s13, s3
    s_and_b32 s13, s13, 0xffff
    s_add_u32 s16, s66, s62
    s_addc_u32 s17, s67, -1
    s_and_b32 s17, s17, 0xffff
    s_add_u32 m0, s56, 0
    s_mul_i32 s1, s0, s54
    s_mul_i32 s63, s0, 1536
    buffer_load_dwordx4 v204, s[8:11], s1 offen lds
    s_and_b32 s58, s2, 31
    s_add_u32 s59, s41, 3
    s_lshl_b32 s59, s59, 5
    s_add_u32 s59, s59, s58
    s_cmp_eq_u32 s50, 0
    s_cselect_b32 s62, 48, 56
    s_cmp_eq_u32 s50, 3
    s_cselect_b32 s62, 0, s62
    s_cmp_gt_u32 s59, 255
    s_cselect_b32 s62, 0, s62
    s_sub_u32 s3, s2, 160
    s_lshl_b32 s3, s3, 2
    s_add_u32 s3, s3, s50
    s_cmp_ge_u32 s41, 5
    s_cselect_b32 s44, s78, s44
    s_cselect_b32 s45, s79, s45
    s_cselect_b32 s59, s3, s59
    s_cselect_b32 s62, 56, s62
    buffer_load_dwordx4 v204, s[12:15], s1 offen offset:1024 lds
    s_and_b32 s3, s3, 127
    s_cmp_eq_u32 s41, 7
    s_cselect_b32 s44, s70, s44
    s_cselect_b32 s45, s71, s45
    s_cselect_b32 s59, s3, s59
    s_cselect_b32 s62, 32, s62
    s_cmp_gt_u32 s50, 3
    s_cselect_b32 s62, 0, s62
    s_mul_i32 s59, s59, s62
    s_lshl_b32 s59, s59, 7
    s_add_u32 s74, s44, s59
    s_addc_u32 s75, s45, 0
    s_bfm_b64 s[76:77], s62, 0
    s_mov_b32 exec_hi, 0
    buffer_load_dwordx4 v205, s[16:19], s63 offen offset:2048 lds
    s_mov_b32 exec_hi, -1
    s_mov_b32 s20, s84
    s_and_b32 s21, s85, 0xffff
    s_mov_b32 s22, 16777216
    s_mov_b32 s23, 0x20000
    s_mov_b32 s24, s82
    s_and_b32 s25, s83, 0xffff
    s_mov_b32 s26, 256
    s_mov_b32 s27, 0x20000
    s_mov_b32 s28, s68
    s_and_b32 s29, s69, 0xffff
    s_mov_b32 s30, 16384
    s_mov_b32 s31, 0x20000
    s_lshl_b32 s3, s41, 2
    s_lshr_b32 s69, 1127358736, s3
    s_and_b32 s69, s69, 15
    s_cmp_eq_u32 s62, 0
    s_cselect_b32 s69, 15, s69
    s_setprio 1
    s_add_u32 m0, s55, 32768
    s_xor_b32 s0, s0, 128
    buffer_load_dwordx4 v200, s[4:7], s0 offen offset:0 lds
    s_and_b32 s52, s50, 3
    s_lshr_b32 s53, s50, 2
    v_and_b32 v8, 31, v1
    v_lshrrev_b32 v9, 5, v1
    v_bfe_u32 v10, v1, 2, 2
    v_and_b32 v11, 3, v1
    v_bfe_u32 v5, v1, 1, 3
    v_xor_b32 v5, v5, v9
    v_lshlrev_b32 v5, 4, v5
    v_lshl_add_u32 v5, v8, 7, v5
    s_lshl_b32 s83, s52, 5
    s_or_b32 s3, s55, s83
    v_xor_b32 v176, s3, v5
    v_xor_b32 v177, 32, v176
    buffer_load_dwordx4 v201, s[4:7], s0 offen offset:1024 lds
    v_xor_b32 v178, 64, v176
    v_xor_b32 v179, 96, v176
    v_xor_b32 v180, 0x4000, v176
    v_xor_b32 v181, 0x4000, v177
    v_xor_b32 v182, 0x4000, v178
    v_xor_b32 v183, 0x4000, v179
    v_add_u32 v184, 0x10000, v176
    v_add_u32 v185, 0x10000, v177
    v_add_u32 v186, 0x10000, v178
    v_add_u32 v187, 0x10000, v179
    v_add_u32 v188, 0x10000, v180
    v_add_u32 v189, 0x10000, v181
    v_add_u32 v190, 0x10000, v182
    v_add_u32 v191, 0x10000, v183
    v_lshlrev_b32 v12, 5, v7
    v_lshl_add_u32 v12, v11, 3, v12
    buffer_load_dwordx4 v202, s[4:7], s0 offen offset:2048 lds
    v_mul_u32_u24 v13, 2560, v9
    v_add_u32 v13, v13, v12
    v_lshrrev_b32 v5, 1, v10
    v_xor_b32 v5, s53, v5
    v_lshlrev_b32 v5, 6, v5
    v_lshl_add_u32 v5, v10, 7, v5
    v_add_u32 v5, v5, v13
    v_lshl_add_u32 v6, v10, 6, v13
    s_xor_b32 s3, s52, 0
    s_mul_i32 s3, s3, 5120
    s_add_u32 s3, s3, 98304
    v_add_u32 v192, s3, v5
    s_add_u32 s3, s3, 2048
    v_add_u32 v196, s3, v6
    s_xor_b32 s3, s52, 1
    s_mul_i32 s3, s3, 5120
    buffer_load_dwordx4 v203, s[4:7], s0 offen offset:3072 lds
    s_add_u32 s3, s3, 98304
    v_add_u32 v193, s3, v5
    s_add_u32 s3, s3, 2048
    v_add_u32 v197, s3, v6
    s_xor_b32 s3, s52, 2
    s_mul_i32 s3, s3, 5120
    s_add_u32 s3, s3, 98304
    v_add_u32 v194, s3, v5
    s_add_u32 s3, s3, 2048
    v_add_u32 v198, s3, v6
    s_xor_b32 s3, s52, 3
    s_mul_i32 s3, s3, 5120
    s_add_u32 s3, s3, 98304
    v_add_u32 v195, s3, v5
    s_add_u32 s3, s3, 2048
    s_add_u32 m0, s56, 20480
    s_mul_i32 s1, s0, s54
    s_mul_i32 s63, s0, 1536
    buffer_load_dwordx4 v204, s[8:11], s1 offen lds
    v_add_u32 v199, s3, v6
    v_mov_b32 v206, 0
    v_mov_b32 v207, 0
    v_mov_b32 v208, 0
    v_mov_b32 v209, 0
    v_mov_b32 v210, 0
    v_mov_b32 v211, 0
    s_lshl_b32 s59, s48, 5
    s_add_u32 s59, s59, s49
    s_lshl_b32 s59, s59, 3
    s_add_u32 s59, s59, s50
    s_lshl_b32 s59, s59, 10
    s_add_u32 s59, s59, 12582912
    s_lshl_b32 s61, s49, 15
    s_add_u32 s61, s61, 10551296
    s_lshl_b32 s60, s48, 12
    buffer_load_dwordx4 v204, s[12:15], s1 offen offset:1024 lds
    s_add_u32 s60, s60, s61
    s_lshl_b32 s3, s48, 13
    s_lshl_b32 s83, s49, 4
    s_add_u32 s82, s3, s83
    s_add_u32 s82, s82, 12058624
    s_sub_u32 s3, s82, s60
    s_sub_u32 s3, s3, 69632
    v_mov_b32 v228, -1
    v_mov_b32 v229, -1
    v_mov_b32 v230, -1
    v_mov_b32 v231, -1
    v_lshlrev_b32 v237, 4, v0
    v_mov_b32 v15, 2130706432
    v_lshl_add_u32 v5, v0, 9, s3
    v_cmp_gt_u32 vcc, 152, v0
    s_nop 1
    v_cndmask_b32 v5, v15, v5, vcc
    s_mov_b32 exec_hi, 0
    buffer_load_dwordx4 v205, s[16:19], s63 offen offset:2048 lds
    s_mov_b32 exec_hi, -1
    v_cmp_gt_u32 vcc, 136, v0
    s_nop 1
    v_cndmask_b32 v5, v5, v237, vcc
    v_cndmask_b32 v237, v15, v237, vcc
    s_lshl_b32 s85, s48, 8
    s_add_u32 s85, s85, s42
    s_lshl_b32 s85, s85, 3
    s_add_u32 s85, s85, 10485760
    v_mov_b32 v217, s85
    s_lshl_b32 s3, s48, 3
    s_add_u32 s3, s3, s50
    s_mul_i32 s3, s3, 144
    s_mul_i32 s83, s40, 36
    s_add_u32 s62, s83, s41
    s_add_u32 s62, s62, 28
    s_add_u32 s62, s62, s3
    s_lshl_b32 s62, s62, 10
    s_setprio 0
    s_waitcnt vmcnt(7)
    s_barrier
    s_cmp_lg_u32 s69, 0
    s_cbranch_scc1 L_t1
    s_mov_b64 exec, s[76:77]
    global_load_dword v255, v219, s[74:75]
    s_mov_b64 exec, -1
L_t1:
    s_mov_b32 m0, 163328
    s_lshl_b32 s3, s49, 9
    s_cmp_eq_u32 s50, 7
    s_cselect_b32 exec_lo, -1, 0
    s_mov_b32 exec_hi, 0
    buffer_load_dwordx4 v232, s[28:31], s3 offen lds
    s_mov_b64 exec, -1
    ds_read_b128 v[96:99], v176 offset:0
    s_add_u32 m0, s55, 65536
    s_xor_b32 s0, s0, 384
    buffer_load_dwordx4 v200, s[4:7], s0 offen offset:0 lds
    ds_read_b64_tr_b16 v[104:105], v196 offset:0
    ds_read_b64_tr_b16 v[106:107], v196 offset:256
    ds_read_b64_tr_b16 v[108:109], v192 offset:0
    ds_read_b64_tr_b16 v[110:111], v192 offset:512
    buffer_load_dwordx4 v201, s[4:7], s0 offen offset:1024 lds
    ds_read_b128 v[100:103], v180 offset:0
    ds_read_b64_tr_b16 v[112:113], v192 offset:1024
    ds_read_b64_tr_b16 v[114:115], v192 offset:1536
    ds_read_b128 v[116:119], v177 offset:0
    buffer_load_dwordx4 v202, s[4:7], s0 offen offset:2048 lds
    ds_read_b64_tr_b16 v[124:125], v197 offset:0
    ds_read_b64_tr_b16 v[126:127], v197 offset:256
    ds_read_b64_tr_b16 v[128:129], v193 offset:0
    ds_read_b64_tr_b16 v[130:131], v193 offset:512
    buffer_load_dwordx4 v203, s[4:7], s0 offen offset:3072 lds
    ds_read_b128 v[120:123], v181 offset:0
    ds_read_b64_tr_b16 v[132:133], v193 offset:1024
    ds_read_b64_tr_b16 v[134:135], v193 offset:1536
    ds_read_b128 v[136:139], v178 offset:0
    s_add_u32 m0, s56, 40960
    s_mul_i32 s1, s0, s54
    s_mul_i32 s63, s0, 1536
    buffer_load_dwordx4 v204, s[8:11], s1 offen lds
    ds_read_b64_tr_b16 v[144:145], v198 offset:0
    ds_read_b64_tr_b16 v[146:147], v198 offset:256
    ds_read_b64_tr_b16 v[148:149], v194 offset:0
    ds_read_b64_tr_b16 v[150:151], v194 offset:512
    buffer_load_dwordx4 v204, s[12:15], s1 offen offset:1024 lds
    ds_read_b128 v[140:143], v182 offset:0
    ds_read_b64_tr_b16 v[152:153], v194 offset:1024
    ds_read_b64_tr_b16 v[154:155], v194 offset:1536
    ds_read_b128 v[156:159], v179 offset:0
    s_mov_b32 exec_hi, 0
    buffer_load_dwordx4 v205, s[16:19], s63 offen offset:2048 lds
    s_mov_b32 exec_hi, -1
    ds_read_b64_tr_b16 v[164:165], v199 offset:0
    ds_read_b64_tr_b16 v[166:167], v199 offset:256
    ds_read_b64_tr_b16 v[168:169], v195 offset:0
    ds_read_b64_tr_b16 v[170:171], v195 offset:512
    ds_read_b128 v[160:163], v183 offset:0
    ds_read_b64_tr_b16 v[172:173], v195 offset:1024
    ds_read_b64_tr_b16 v[174:175], v195 offset:1536
    buffer_store_dwordx4 v[228:231], v5, s[20:23], s60 offen sc1
    buffer_store_dwordx4 v[228:231], v232, s[20:23], s59 offen sc1
    s_cmp_lg_u32 s69, 1
    s_cbranch_scc1 L_t2
    s_mov_b64 exec, s[76:77]
    global_load_dword v255, v219, s[74:75]
    s_mov_b64 exec, -1
L_t2:
    s_waitcnt lgkmcnt(0)
    s_cmp_lt_u32 s50, 4
    s_cbranch_scc1 L_a0
    s_waitcnt vmcnt(9)
    s_barrier
L_a0:
    v_mfma_f32_32x32x16_bf16 v[16:31], v[104:107], v[96:99], 0
    s_setprio 1
    v_lshlrev_b32 v212, 16, v104
    v_lshlrev_b32 v240, 16, v220
    v_and_b32 v241, 0xffff0000, v220
    v_and_b32 v213, 0xffff0000, v104
    v_lshlrev_b32 v242, 16, v221
    v_add_f32 v206, v206, v212
    v_mfma_f32_32x32x16_bf16 v[32:47], v[108:111], v[96:99], 0
    v_and_b32 v243, 0xffff0000, v221
    v_add_f32 v207, v207, v213
    v_lshlrev_b32 v244, 16, v222
    v_lshlrev_b32 v214, 16, v105
    v_and_b32 v245, 0xffff0000, v222
    v_mfma_f32_32x32x16_bf16 v[48:63], v[108:111], v[100:103], 0
    v_and_b32 v215, 0xffff0000, v105
    v_lshlrev_b32 v246, 16, v223
    v_add_f32 v206, v206, v214
    v_and_b32 v247, 0xffff0000, v223
    v_add_f32 v207, v207, v215
    v_mfma_f32_32x32x16_bf16 v[64:79], v[112:115], v[96:99], 0
    v_pk_add_f32 v[248:249], v[240:241], v[242:243]
    v_lshlrev_b32 v212, 16, v106
    v_pk_add_f32 v[250:251], v[244:245], v[246:247]
    v_and_b32 v213, 0xffff0000, v106
    v_pk_add_f32 v[248:249], v[248:249], v[250:251]
    v_mfma_f32_32x32x16_bf16 v[80:95], v[112:115], v[100:103], 0
    v_add_f32 v206, v206, v212
    v_add_f32 v248, v248, v249
    v_add_f32 v207, v207, v213
    s_nop 0
    v_add_f32_dpp v248, v248, v248 row_shr:1 row_mask:0xf bank_mask:0xf bound_ctrl:0
    v_lshlrev_b32 v214, 16, v107
    v_mfma_f32_32x32x16_bf16 v[16:31], v[124:127], v[116:119], v[16:31]
    v_add_f32_dpp v248, v248, v248 row_shr:2 row_mask:0xf bank_mask:0xf bound_ctrl:0
    v_and_b32 v215, 0xffff0000, v107
    s_nop 0
    v_add_f32_dpp v248, v248, v248 row_shr:4 row_mask:0xf bank_mask:0xf bound_ctrl:0
    v_add_f32 v206, v206, v214
    s_nop 0
    v_add_f32_dpp v248, v248, v248 row_shr:8 row_mask:0xf bank_mask:0xf bound_ctrl:0
    v_mfma_f32_32x32x16_bf16 v[32:47], v[128:131], v[116:119], v[32:47]
    v_add_f32 v207, v207, v215
    v_add_f32_dpp v248, v248, v248 row_bcast:15 row_mask:0xa bank_mask:0xf
    v_lshlrev_b32 v212, 16, v108
    s_nop 0
    v_add_f32_dpp v248, v248, v248 row_bcast:31 row_mask:0xc bank_mask:0xf
    v_and_b32 v213, 0xffff0000, v108
    v_readlane_b32 s3, v248, 63
    v_mfma_f32_32x32x16_bf16 v[48:63], v[128:131], v[120:123], v[48:63]
    v_add_f32 v208, v208, v212
    v_mov_b32 v250, 0xbb000000
    v_add_f32 v209, v209, v213
    v_mul_f32 v250, s3, v250
    v_lshlrev_b32 v214, 16, v109
    v_mfma_f32_32x32x16_bf16 v[64:79], v[132:135], v[116:119], v[64:79]
    v_mov_b32 v251, v250
    v_and_b32 v215, 0xffff0000, v109
    v_pk_add_f32 v[240:241], v[240:241], v[250:251]
    v_add_f32 v208, v208, v214
    v_pk_add_f32 v[242:243], v[242:243], v[250:251]
    v_mfma_f32_32x32x16_bf16 v[80:95], v[132:135], v[120:123], v[80:95]
    v_add_f32 v209, v209, v215
    v_pk_add_f32 v[244:245], v[244:245], v[250:251]
    v_lshlrev_b32 v212, 16, v110
    v_pk_add_f32 v[246:247], v[246:247], v[250:251]
    v_pk_mul_f32 v[248:249], v[240:241], v[240:241]
    v_mfma_f32_32x32x16_bf16 v[16:31], v[144:147], v[136:139], v[16:31]
    v_and_b32 v213, 0xffff0000, v110
    v_pk_fma_f32 v[248:249], v[242:243], v[242:243], v[248:249]
    v_add_f32 v208, v208, v212
    v_pk_fma_f32 v[248:249], v[244:245], v[244:245], v[248:249]
    v_add_f32 v209, v209, v213
    v_mfma_f32_32x32x16_bf16 v[32:47], v[148:151], v[136:139], v[32:47]
    v_pk_fma_f32 v[248:249], v[246:247], v[246:247], v[248:249]
    v_lshlrev_b32 v214, 16, v111
    v_add_f32 v248, v248, v249
    v_and_b32 v215, 0xffff0000, v111
    s_nop 0
    v_add_f32_dpp v248, v248, v248 row_shr:1 row_mask:0xf bank_mask:0xf bound_ctrl:0
    v_mfma_f32_32x32x16_bf16 v[48:63], v[148:151], v[140:143], v[48:63]
    v_add_f32 v208, v208, v214
    v_add_f32_dpp v248, v248, v248 row_shr:2 row_mask:0xf bank_mask:0xf bound_ctrl:0
    v_add_f32 v209, v209, v215
    s_nop 0
    v_add_f32_dpp v248, v248, v248 row_shr:4 row_mask:0xf bank_mask:0xf bound_ctrl:0
    v_lshlrev_b32 v212, 16, v112
    s_nop 0
    v_add_f32_dpp v248, v248, v248 row_shr:8 row_mask:0xf bank_mask:0xf bound_ctrl:0
    v_mfma_f32_32x32x16_bf16 v[64:79], v[152:155], v[136:139], v[64:79]
    v_and_b32 v213, 0xffff0000, v112
    v_add_f32_dpp v248, v248, v248 row_bcast:15 row_mask:0xa bank_mask:0xf
    v_add_f32 v210, v210, v212
    s_nop 0
    v_add_f32_dpp v248, v248, v248 row_bcast:31 row_mask:0xc bank_mask:0xf
    v_add_f32 v211, v211, v213
    v_mfma_f32_32x32x16_bf16 v[80:95], v[152:155], v[140:143], v[80:95]
    v_readlane_b32 s3, v248, 63
    v_lshlrev_b32 v214, 16, v113
    v_mov_b32 v248, 0x3b000000
    v_and_b32 v215, 0xffff0000, v113
    v_mul_f32 v248, s3, v248
    v_mfma_f32_32x32x16_bf16 v[16:31], v[164:167], v[156:159], v[16:31]
    v_add_f32 v210, v210, v214
    v_cvt_pk_bf16_f32 v224, v250, v250
    v_add_f32 v211, v211, v215
    v_cvt_pk_bf16_f32 v248, v248, v248
    v_lshlrev_b32 v212, 16, v114
    v_mfma_f32_32x32x16_bf16 v[32:47], v[168:171], v[156:159], v[32:47]
    v_lshlrev_b32 v248, 16, v248
    v_and_b32 v213, 0xffff0000, v114
    v_add_f32 v248, 0x3727c5ac, v248
    v_add_f32 v210, v210, v212
    v_cvt_pk_bf16_f32 v248, v248, v248
    v_mfma_f32_32x32x16_bf16 v[48:63], v[168:171], v[160:163], v[48:63]
    v_add_f32 v211, v211, v213
    v_lshlrev_b32 v248, 16, v248
    v_lshlrev_b32 v214, 16, v115
    v_sqrt_f32 v248, v248
    v_and_b32 v215, 0xffff0000, v115
    v_mfma_f32_32x32x16_bf16 v[64:79], v[172:175], v[156:159], v[64:79]
    v_cvt_pk_bf16_f32 v248, v248, v248
    v_add_f32 v210, v210, v214
    v_lshlrev_b32 v248, 16, v248
    v_add_f32 v211, v211, v215
    v_rcp_f32 v225, v248
    v_mfma_f32_32x32x16_bf16 v[80:95], v[172:175], v[160:163], v[80:95]
    s_setprio 0
    s_cmp_ge_u32 s50, 4
    s_cbranch_scc1 L_b0
    s_waitcnt vmcnt(9)
    s_barrier
L_b0:
    ds_read_b128 v[96:99], v176 offset:32768
    s_add_u32 m0, s55, 0
    s_xor_b32 s0, s0, 128
    buffer_load_dwordx4 v200, s[4:7], s0 offen offset:0 lds
    ds_read_b64_tr_b16 v[104:105], v196 offset:20480
    ds_read_b64_tr_b16 v[106:107], v196 offset:20736
    ds_read_b64_tr_b16 v[108:109], v192 offset:20480
    ds_read_b64_tr_b16 v[110:111], v192 offset:20992
    buffer_load_dwordx4 v201, s[4:7], s0 offen offset:1024 lds
    ds_read_b128 v[100:103], v180 offset:32768
    ds_read_b64_tr_b16 v[112:113], v192 offset:21504
    ds_read_b64_tr_b16 v[114:115], v192 offset:22016
    ds_read_b128 v[116:119], v177 offset:32768
    buffer_load_dwordx4 v202, s[4:7], s0 offen offset:2048 lds
    ds_read_b64_tr_b16 v[124:125], v197 offset:20480
    ds_read_b64_tr_b16 v[126:127], v197 offset:20736
    ds_read_b64_tr_b16 v[128:129], v193 offset:20480
    ds_read_b64_tr_b16 v[130:131], v193 offset:20992
    buffer_load_dwordx4 v203, s[4:7], s0 offen offset:3072 lds
    ds_read_b128 v[120:123], v181 offset:32768
    ds_read_b64_tr_b16 v[132:133], v193 offset:21504
    ds_read_b64_tr_b16 v[134:135], v193 offset:22016
    ds_read_b128 v[136:139], v178 offset:32768
    s_add_u32 m0, s56, 0
    s_mul_i32 s1, s0, s54
    s_mul_i32 s63, s0, 1536
    buffer_load_dwordx4 v204, s[8:11], s1 offen lds
    ds_read_b64_tr_b16 v[144:145], v198 offset:20480
    ds_read_b64_tr_b16 v[146:147], v198 offset:20736
    ds_read_b64_tr_b16 v[148:149], v194 offset:20480
    ds_read_b64_tr_b16 v[150:151], v194 offset:20992
    buffer_load_dwordx4 v204, s[12:15], s1 offen offset:1024 lds
    ds_read_b128 v[140:143], v182 offset:32768
    ds_read_b64_tr_b16 v[152:153], v194 offset:21504
    ds_read_b64_tr_b16 v[154:155], v194 offset:22016
    ds_read_b128 v[156:159], v179 offset:32768
    s_mov_b32 exec_hi, 0
    buffer_load_dwordx4 v205, s[16:19], s63 offen offset:2048 lds
    s_mov_b32 exec_hi, -1
    ds_read_b64_tr_b16 v[164:165], v199 offset:20480
    ds_read_b64_tr_b16 v[166:167], v199 offset:20736
    ds_read_b64_tr_b16 v[168:169], v195 offset:20480
    ds_read_b64_tr_b16 v[170:171], v195 offset:20992
    ds_read_b128 v[160:163], v183 offset:32768
    ds_read_b64_tr_b16 v[172:173], v195 offset:21504
    ds_read_b64_tr_b16 v[174:175], v195 offset:22016
    s_mov_b64 exec, 1
    buffer_store_dwordx2 v[224:225], v217, s[20:23], 0 offen sc1
    s_mov_b64 exec, -1
    s_cmp_lg_u32 s69, 2
    s_cbranch_scc1 L_t3
    s_mov_b64 exec, s[76:77]
    global_load_dword v255, v219, s[74:75]
    s_mov_b64 exec, -1
L_t3:
    s_waitcnt lgkmcnt(0)
    s_cmp_lt_u32 s50, 4
    s_cbranch_scc1 L_a1
    s_waitcnt vmcnt(10)
    s_barrier
L_a1:
    v_mfma_f32_32x32x16_bf16 v[16:31], v[104:107], v[96:99], v[16:31]
    s_setprio 1
    v_lshlrev_b32 v212, 16, v104
    s_lshr_b32 s29, s50, 1
    v_and_b32 v213, 0xffff0000, v104
    s_lshl_b32 s30, s41, 7
    v_add_f32 v206, v206, v212
    v_mfma_f32_32x32x16_bf16 v[32:47], v[108:111], v[96:99], v[32:47]
    s_add_u32 s32, s78, s30
    v_add_f32 v207, v207, v213
    s_addc_u32 s33, s79, 0
    v_lshlrev_b32 v214, 16, v105
    s_and_b32 s33, s33, 0xffff
    v_mfma_f32_32x32x16_bf16 v[48:63], v[108:111], v[100:103], v[48:63]
    v_and_b32 v215, 0xffff0000, v105
    s_sub_u32 s34, 1835008, s30
    v_add_f32 v206, v206, v214
    s_mov_b32 s35, 0x20000
    v_add_f32 v207, v207, v215
    v_mfma_f32_32x32x16_bf16 v[64:79], v[112:115], v[96:99], v[64:79]
    s_lshl_b32 s3, s29, 17
    v_lshlrev_b32 v212, 16, v106
    s_add_u32 s3, s3, s30
    v_and_b32 v213, 0xffff0000, v106
    s_add_u32 s36, s70, s3
    v_mfma_f32_32x32x16_bf16 v[80:95], v[112:115], v[100:103], v[80:95]
    v_add_f32 v206, v206, v212
    s_addc_u32 s37, s71, 0
    v_add_f32 v207, v207, v213
    s_and_b32 s37, s37, 0xffff
    v_lshlrev_b32 v214, 16, v107
    v_mfma_f32_32x32x16_bf16 v[16:31], v[124:127], v[116:119], v[16:31]
    s_sub_u32 s38, 524288, s3
    v_and_b32 v215, 0xffff0000, v107
    s_mov_b32 s39, 0x20000
    v_add_f32 v206, v206, v214
    s_mov_b32 s70, s29
    v_mfma_f32_32x32x16_bf16 v[32:47], v[128:131], v[116:119], v[32:47]
    v_add_f32 v207, v207, v215
    v_lshlrev_b32 v212, 16, v108
    s_lshl_b32 s71, s48, 8
    v_and_b32 v213, 0xffff0000, v108
    s_mov_b32 s79, s40
    v_mfma_f32_32x32x16_bf16 v[48:63], v[128:131], v[120:123], v[48:63]
    v_add_f32 v208, v208, v212
    s_mov_b32 s84, s41
    v_add_f32 v209, v209, v213
    s_and_b32 s3, s2, 7
    v_lshlrev_b32 v214, 16, v109
    v_mfma_f32_32x32x16_bf16 v[64:79], v[132:135], v[116:119], v[64:79]
    s_lshl_b32 s3, s3, 2
    v_and_b32 v215, 0xffff0000, v109
    s_bfe_u32 s29, s2, 0x20003
    v_add_f32 v208, v208, v214
    s_add_u32 s85, s3, s29
    v_mfma_f32_32x32x16_bf16 v[80:95], v[132:135], v[120:123], v[80:95]
    v_add_f32 v209, v209, v215
    s_lshl_b32 s3, s85, 16
    v_lshlrev_b32 v212, 16, v110
    s_add_u32 s3, s3, s30
    v_mfma_f32_32x32x16_bf16 v[16:31], v[144:147], v[136:139], v[16:31]
    v_and_b32 v213, 0xffff0000, v110
    s_add_u32 s40, s64, s3
    v_add_f32 v208, v208, v212
    s_addc_u32 s41, s65, 0
    v_add_f32 v209, v209, v213
    v_mfma_f32_32x32x16_bf16 v[32:47], v[148:151], v[136:139], v[32:47]
    s_and_b32 s41, s41, 0xffff
    v_lshlrev_b32 v214, 16, v111
    s_sub_u32 s42, 0x10000, s30
    v_and_b32 v215, 0xffff0000, v111
    s_mov_b32 s43, 0x20000
    v_mfma_f32_32x32x16_bf16 v[48:63], v[148:151], v[140:143], v[48:63]
    v_add_f32 v208, v208, v214
    s_add_u32 s44, s80, s3
    v_add_f32 v209, v209, v215
    v_lshlrev_b32 v212, 16, v112
    s_addc_u32 s45, s81, 0
    v_mfma_f32_32x32x16_bf16 v[64:79], v[152:155], v[136:139], v[64:79]
    v_and_b32 v213, 0xffff0000, v112
    s_and_b32 s45, s45, 0xffff
    v_add_f32 v210, v210, v212
    s_mov_b32 s46, s42
    v_add_f32 v211, v211, v213
    v_mfma_f32_32x32x16_bf16 v[80:95], v[152:155], v[140:143], v[80:95]
    s_mov_b32 s47, 0x20000
    v_lshlrev_b32 v214, 16, v113
    s_lshl_b32 s3, s50, 9
    v_and_b32 v215, 0xffff0000, v113
    s_add_u32 s64, s82, s3
    v_mfma_f32_32x32x16_bf16 v[16:31], v[164:167], v[156:159], v[16:31]
    v_add_f32 v210, v210, v214
    s_and_b32 s29, s50, 1
    v_add_f32 v211, v211, v215
    s_lshl_b32 s67, s29, 15
    v_lshlrev_b32 v212, 16, v114
    v_mfma_f32_32x32x16_bf16 v[32:47], v[168:171], v[156:159], v[32:47]
    s_bfe_u32 s3, s2, 0x20003
    v_and_b32 v213, 0xffff0000, v114
    s_lshl_b32 s3, s3, 1
    v_add_f32 v210, v210, v212
    s_add_u32 s78, s3, s84
    v_mfma_f32_32x32x16_bf16 v[48:63], v[168:171], v[160:163], v[48:63]
    v_add_f32 v211, v211, v213
    s_mul_i32 s78, s78, 1
    v_lshlrev_b32 v214, 16, v115
    s_sub_u32 s3, s78, 7
    v_and_b32 v215, 0xffff0000, v115
    v_mfma_f32_32x32x16_bf16 v[64:79], v[172:175], v[156:159], v[64:79]
    s_min_u32 s28, s3, s78
    v_add_f32 v210, v210, v214
    s_add_u32 s68, s28, s29
    v_add_f32 v211, v211, v215
    v_mfma_f32_32x32x16_bf16 v[80:95], v[172:175], v[160:163], v[80:95]
    s_setprio 0
    s_cmp_ge_u32 s50, 4
    s_cbranch_scc1 L_b1
    s_waitcnt vmcnt(10)
    s_barrier
L_b1:
    ds_read_b128 v[96:99], v184 offset:0
    s_add_u32 m0, s55, 32768
    s_xor_b32 s0, s0, 896
    buffer_load_dwordx4 v200, s[4:7], s0 offen offset:0 lds
    ds_read_b64_tr_b16 v[104:105], v196 offset:40960
    ds_read_b64_tr_b16 v[106:107], v196 offset:41216
    ds_read_b64_tr_b16 v[108:109], v192 offset:40960
    ds_read_b64_tr_b16 v[110:111], v192 offset:41472
    buffer_load_dwordx4 v201, s[4:7], s0 offen offset:1024 lds
    ds_read_b128 v[100:103], v188 offset:0
    ds_read_b64_tr_b16 v[112:113], v192 offset:41984
    ds_read_b64_tr_b16 v[114:115], v192 offset:42496
    ds_read_b128 v[116:119], v185 offset:0
    buffer_load_dwordx4 v202, s[4:7], s0 offen offset:2048 lds
    ds_read_b64_tr_b16 v[124:125], v197 offset:40960
    ds_read_b64_tr_b16 v[126:127], v197 offset:41216
    ds_read_b64_tr_b16 v[128:129], v193 offset:40960
    ds_read_b64_tr_b16 v[130:131], v193 offset:41472
    buffer_load_dwordx4 v203, s[4:7], s0 offen offset:3072 lds
    ds_read_b128 v[120:123], v189 offset:0
    ds_read_b64_tr_b16 v[132:133], v193 offset:41984
    ds_read_b64_tr_b16 v[134:135], v193 offset:42496
    ds_read_b128 v[136:139], v186 offset:0
    s_add_u32 m0, s56, 20480
    s_mul_i32 s1, s0, s54
    s_mul_i32 s63, s0, 1536
    buffer_load_dwordx4 v204, s[8:11], s1 offen lds
    ds_read_b64_tr_b16 v[144:145], v198 offset:40960
    ds_read_b64_tr_b16 v[146:147], v198 offset:41216
    ds_read_b64_tr_b16 v[148:149], v194 offset:40960
    ds_read_b64_tr_b16 v[150:151], v194 offset:41472
    buffer_load_dwordx4 v204, s[12:15], s1 offen offset:1024 lds
    ds_read_b128 v[140:143], v190 offset:0
    ds_read_b64_tr_b16 v[152:153], v194 offset:41984
    ds_read_b64_tr_b16 v[154:155], v194 offset:42496
    ds_read_b128 v[156:159], v187 offset:0
    s_mov_b32 exec_hi, 0
    buffer_load_dwordx4 v205, s[16:19], s63 offen offset:2048 lds
    s_mov_b32 exec_hi, -1
    ds_read_b64_tr_b16 v[164:165], v199 offset:40960
    ds_read_b64_tr_b16 v[166:167], v199 offset:41216
    ds_read_b64_tr_b16 v[168:169], v195 offset:40960
    ds_read_b64_tr_b16 v[170:171], v195 offset:41472
    ds_read_b128 v[160:163], v191 offset:0
    ds_read_b64_tr_b16 v[172:173], v195 offset:41984
    ds_read_b64_tr_b16 v[174:175], v195 offset:42496
    s_cmp_lg_u32 s69, 3
    s_cbranch_scc1 L_t4
    s_mov_b64 exec, s[76:77]
    global_load_dword v255, v219, s[74:75]
    s_mov_b64 exec, -1
L_t4:
    s_waitcnt lgkmcnt(0)
    s_cmp_lt_u32 s50, 4
    s_cbranch_scc1 L_a2
    s_waitcnt vmcnt(8)
    s_barrier
L_a2:
    v_mfma_f32_32x32x16_bf16 v[16:31], v[104:107], v[96:99], v[16:31]
    s_setprio 1
    v_lshlrev_b32 v212, 16, v104
    s_lshl_b32 s85, s85, 1
    v_and_b32 v213, 0xffff0000, v104
    s_add_u32 s85, s85, s29
    v_add_f32 v206, v206, v212
    v_mfma_f32_32x32x16_bf16 v[32:47], v[108:111], v[96:99], v[32:47]
    s_mul_i32 s66, s85, 144
    v_add_f32 v207, v207, v213
    s_mul_i32 s3, s70, 36
    v_lshlrev_b32 v214, 16, v105
    s_add_u32 s66, s66, s3
    v_mfma_f32_32x32x16_bf16 v[48:63], v[108:111], v[100:103], v[48:63]
    v_and_b32 v215, 0xffff0000, v105
    s_lshl_b32 s66, s66, 10
    v_add_f32 v206, v206, v214
    s_lshr_b32 s65, s85, 3
    v_add_f32 v207, v207, v215
    v_mfma_f32_32x32x16_bf16 v[64:79], v[112:115], v[96:99], v[64:79]
    s_lshl_b32 s65, s65, 13
    v_lshlrev_b32 v212, 16, v106
    s_lshl_b32 s3, s70, 7
    v_and_b32 v213, 0xffff0000, v106
    s_add_u32 s65, s65, s3
    v_mfma_f32_32x32x16_bf16 v[80:95], v[112:115], v[100:103], v[80:95]
    v_add_f32 v206, v206, v212
    s_add_u32 s65, s65, 12058624
    v_add_f32 v207, v207, v213
    s_and_b32 s3, s85, 7
    v_lshlrev_b32 v214, 16, v107
    v_mfma_f32_32x32x16_bf16 v[16:31], v[124:127], v[116:119], v[16:31]
    s_lshl_b32 s3, s3, 9
    v_and_b32 v215, 0xffff0000, v107
    s_add_u32 s80, s65, s3
    v_add_f32 v206, v206, v214
    s_and_b32 s3, s3, 0x600
    v_mfma_f32_32x32x16_bf16 v[32:47], v[128:131], v[116:119], v[32:47]
    v_add_f32 v207, v207, v215
    s_add_u32 s65, s65, s3
    v_lshlrev_b32 v212, 16, v108
    s_lshl_b32 s3, s50, 5
    v_and_b32 v213, 0xffff0000, v108
    v_mfma_f32_32x32x16_bf16 v[48:63], v[128:131], v[120:123], v[48:63]
    s_add_u32 s71, s71, s3
    v_add_f32 v208, v208, v212
    s_lshl_b32 s71, s71, 3
    v_add_f32 v209, v209, v213
    s_add_u32 s71, s71, 10485760
    v_mfma_f32_32x32x16_bf16 v[64:79], v[132:135], v[116:119], v[64:79]
    v_lshlrev_b32 v214, 16, v109
    s_lshl_b32 s3, s48, 3
    v_and_b32 v215, 0xffff0000, v109
    s_add_u32 s30, s3, s50
    v_add_f32 v208, v208, v214
    v_mfma_f32_32x32x16_bf16 v[80:95], v[132:135], v[120:123], v[80:95]
    s_mul_i32 s30, s30, 144
    v_add_f32 v209, v209, v215
    v_lshlrev_b32 v212, 16, v110
    s_mul_i32 s29, s79, 36
    v_and_b32 v213, 0xffff0000, v110
    v_mfma_f32_32x32x16_bf16 v[16:31], v[144:147], v[136:139], v[16:31]
    s_mul_i32 s81, s53, 14
    v_add_f32 v208, v208, v212
    s_add_u32 s29, s29, s81
    v_add_f32 v209, v209, v213
    s_lshl_b32 s81, s84, 1
    v_mfma_f32_32x32x16_bf16 v[32:47], v[148:151], v[136:139], v[32:47]
    v_lshlrev_b32 v214, 16, v111
    s_add_u32 s29, s29, s81
    v_and_b32 v215, 0xffff0000, v111
    s_add_u32 s57, s30, s29
    v_add_f32 v208, v208, v214
    v_mfma_f32_32x32x16_bf16 v[48:63], v[148:151], v[140:143], v[48:63]
    s_lshl_b32 s57, s57, 10
    v_add_f32 v209, v209, v215
    s_xor_b32 s81, s50, 4
    v_lshlrev_b32 v212, 16, v112
    s_add_u32 s81, s3, s81
    v_mfma_f32_32x32x16_bf16 v[64:79], v[152:155], v[136:139], v[64:79]
    v_and_b32 v213, 0xffff0000, v112
    s_mul_i32 s81, s81, 144
    v_add_f32 v210, v210, v212
    s_add_u32 s58, s81, s29
    v_add_f32 v211, v211, v213
    v_mfma_f32_32x32x16_bf16 v[80:95], v[152:155], v[140:143], v[80:95]
    s_lshl_b32 s58, s58, 10
    v_lshlrev_b32 v214, 16, v113
    s_mov_b32 s72, 0x3fb8aa3b
    v_and_b32 v215, 0xffff0000, v113
    s_mov_b32 s73, 0x3fb8aa3b
    v_mfma_f32_32x32x16_bf16 v[16:31], v[164:167], v[156:159], v[16:31]
    v_add_f32 v210, v210, v214
    s_lshl_b32 s3, s48, 5
    v_add_f32 v211, v211, v215
    s_lshl_b32 s81, s79, 3
    v_lshlrev_b32 v212, 16, v114
    v_mfma_f32_32x32x16_bf16 v[32:47], v[168:171], v[156:159], v[32:47]
    s_add_u32 s3, s3, s81
    v_and_b32 v213, 0xffff0000, v114
    s_lshl_b32 s81, s53, 1
    v_add_f32 v210, v210, v212
    s_add_u32 s3, s3, s81
    v_mfma_f32_32x32x16_bf16 v[48:63], v[168:171], v[160:163], v[48:63]
    v_add_f32 v211, v211, v213
    s_lshl_b32 s3, s3, 3
    v_lshlrev_b32 v214, 16, v115
    s_add_u32 s3, s3, s50
    v_and_b32 v215, 0xffff0000, v115
    v_mfma_f32_32x32x16_bf16 v[64:79], v[172:175], v[156:159], v[64:79]
    s_lshl_b32 s3, s3, 10
    v_add_f32 v210, v210, v214
    s_add_u32 s3, s3, 12582912
    v_add_f32 v211, v211, v215
    v_mfma_f32_32x32x16_bf16 v[80:95], v[172:175], v[160:163], v[80:95]
    s_setprio 0
    s_cmp_ge_u32 s50, 4
    s_cbranch_scc1 L_b2
    s_waitcnt vmcnt(8)
    s_barrier
L_b2:
    ds_read_b128 v[96:99], v176 offset:0
    s_add_u32 m0, s55, 65536
    s_xor_b32 s0, s0, 128
    buffer_load_dwordx4 v200, s[4:7], s0 offen offset:0 lds
    ds_read_b64_tr_b16 v[104:105], v196 offset:0
    ds_read_b64_tr_b16 v[106:107], v196 offset:256
    ds_read_b64_tr_b16 v[108:109], v192 offset:0
    ds_read_b64_tr_b16 v[110:111], v192 offset:512
    buffer_load_dwordx4 v201, s[4:7], s0 offen offset:1024 lds
    ds_read_b128 v[100:103], v180 offset:0
    ds_read_b64_tr_b16 v[112:113], v192 offset:1024
    ds_read_b64_tr_b16 v[114:115], v192 offset:1536
    ds_read_b128 v[116:119], v177 offset:0
    buffer_load_dwordx4 v202, s[4:7], s0 offen offset:2048 lds
    ds_read_b64_tr_b16 v[124:125], v197 offset:0
    ds_read_b64_tr_b16 v[126:127], v197 offset:256
    ds_read_b64_tr_b16 v[128:129], v193 offset:0
    ds_read_b64_tr_b16 v[130:131], v193 offset:512
    buffer_load_dwordx4 v203, s[4:7], s0 offen offset:3072 lds
    ds_read_b128 v[120:123], v181 offset:0
    ds_read_b64_tr_b16 v[132:133], v193 offset:1024
    ds_read_b64_tr_b16 v[134:135], v193 offset:1536
    ds_read_b128 v[136:139], v178 offset:0
    s_add_u32 m0, s56, 40960
    s_mul_i32 s1, s0, s54
    s_mul_i32 s63, s0, 1536
    buffer_load_dwordx4 v204, s[8:11], s1 offen lds
    ds_read_b64_tr_b16 v[144:145], v198 offset:0
    ds_read_b64_tr_b16 v[146:147], v198 offset:256
    ds_read_b64_tr_b16 v[148:149], v194 offset:0
    ds_read_b64_tr_b16 v[150:151], v194 offset:512
    buffer_load_dwordx4 v204, s[12:15], s1 offen offset:1024 lds
    ds_read_b128 v[140:143], v182 offset:0
    ds_read_b64_tr_b16 v[152:153], v194 offset:1024
    ds_read_b64_tr_b16 v[154:155], v194 offset:1536
    ds_read_b128 v[156:159], v179 offset:0
    s_mov_b32 exec_hi, 0
    buffer_load_dwordx4 v205, s[16:19], s63 offen offset:2048 lds
    s_mov_b32 exec_hi, -1
    ds_read_b64_tr_b16 v[164:165], v199 offset:0
    ds_read_b64_tr_b16 v[166:167], v199 offset:256
    ds_read_b64_tr_b16 v[168:169], v195 offset:0
    ds_read_b64_tr_b16 v[170:171], v195 offset:512
    ds_read_b128 v[160:163], v183 offset:0
    ds_read_b64_tr_b16 v[172:173], v195 offset:1024
    ds_read_b64_tr_b16 v[174:175], v195 offset:1536
    s_cmp_lg_u32 s69, 4
    s_cbranch_scc1 L_t5
    s_mov_b64 exec, s[76:77]
    global_load_dword v255, v219, s[74:75]
    s_mov_b64 exec, -1
L_t5:
    s_waitcnt lgkmcnt(0)
    s_cmp_lt_u32 s50, 4
    s_cbranch_scc1 L_a3
    s_waitcnt vmcnt(7)
    s_barrier
L_a3:
    v_mfma_f32_32x32x16_bf16 v[16:31], v[104:107], v[96:99], v[16:31]
    s_setprio 1
    v_lshlrev_b32 v212, 16, v104
    s_xor_b32 s81, s3, 0x1000
    v_and_b32 v213, 0xffff0000, v104
    s_cmp_eq_u32 s51, 1
    v_add_f32 v206, v206, v212
    v_mfma_f32_32x32x16_bf16 v[32:47], v[108:111], v[96:99], v[32:47]
    s_cselect_b32 s57, s3, s57
    v_add_f32 v207, v207, v213
    s_cselect_b32 s58, s81, s58
    v_lshlrev_b32 v214, 16, v105
    s_and_b32 s84, s84, 2
    v_mfma_f32_32x32x16_bf16 v[48:63], v[108:111], v[100:103], v[48:63]
    v_and_b32 v215, 0xffff0000, v105
    s_lshl_b32 s84, s84, 1
    v_add_f32 v206, v206, v214
    s_add_u32 s84, s84, s52
    v_add_f32 v207, v207, v215
    v_mfma_f32_32x32x16_bf16 v[64:79], v[112:115], v[96:99], v[64:79]
    s_lshl_b32 s84, s84, 9
    v_lshlrev_b32 v212, 16, v106
    s_or_b32 s3, s82, 0x70
    v_and_b32 v213, 0xffff0000, v106
    s_add_u32 s84, s84, s3
    v_mfma_f32_32x32x16_bf16 v[80:95], v[112:115], v[100:103], v[80:95]
    v_add_f32 v206, v206, v212
    v_lshlrev_b32 v15, 5, v8
    v_add_f32 v207, v207, v213
    v_lshl_add_u32 v15, v9, 4, v15
    v_lshlrev_b32 v214, 16, v107
    v_mfma_f32_32x32x16_bf16 v[16:31], v[124:127], v[116:119], v[16:31]
    v_add_u32 v234, 157696, v15
    v_and_b32 v215, 0xffff0000, v107
    v_lshl_add_u32 v233, s52, 2, v234
    v_add_f32 v206, v206, v214
    s_mul_i32 s3, s50, 3328
    v_mfma_f32_32x32x16_bf16 v[32:47], v[128:131], v[116:119], v[32:47]
    v_add_f32 v207, v207, v215
    s_add_u32 s3, s3, 131072
    v_lshlrev_b32 v212, 16, v108
    v_lshrrev_b32 v15, 1, v8
    v_and_b32 v213, 0xffff0000, v108
    v_mfma_f32_32x32x16_bf16 v[48:63], v[128:131], v[120:123], v[48:63]
    v_add_u32 v15, v15, v9
    v_add_f32 v208, v208, v212
    v_lshlrev_b32 v15, 3, v15
    v_add_f32 v209, v209, v213
    v_lshl_add_u32 v15, v8, 6, v15
    v_mfma_f32_32x32x16_bf16 v[64:79], v[132:135], v[116:119], v[64:79]
    v_lshlrev_b32 v214, 16, v109
    v_add_u32 v239, s3, v15
    v_and_b32 v215, 0xffff0000, v109
    v_lshrrev_b32 v15, 2, v8
    v_add_f32 v208, v208, v214
    v_mfma_f32_32x32x16_bf16 v[80:95], v[132:135], v[120:123], v[80:95]
    v_add_u32 v15, v15, v9
    v_add_f32 v209, v209, v215
    v_lshlrev_b32 v15, 3, v15
    v_lshlrev_b32 v212, 16, v110
    v_lshl_add_u32 v15, v8, 5, v15
    v_mfma_f32_32x32x16_bf16 v[16:31], v[144:147], v[136:139], v[16:31]
    v_and_b32 v213, 0xffff0000, v110
    s_add_u32 s3, s3, 2176
    v_add_f32 v208, v208, v212
    v_add_u32 v240, s3, v15
    v_add_f32 v209, v209, v213
    v_mfma_f32_32x32x16_bf16 v[32:47], v[148:151], v[136:139], v[32:47]
    v_lshrrev_b32 v15, 2, v1
    v_lshlrev_b32 v214, 16, v111
    s_and_b32 s81, s50, 1
    v_and_b32 v215, 0xffff0000, v111
    s_lshl_b32 s3, s81, 5
    v_mfma_f32_32x32x16_bf16 v[48:63], v[148:151], v[140:143], v[48:63]
    v_add_f32 v208, v208, v214
    s_add_u32 s3, s3, 131072
    v_add_f32 v209, v209, v215
    v_add_u32 v6, v2, v11
    v_lshlrev_b32 v212, 16, v112
    v_mfma_f32_32x32x16_bf16 v[64:79], v[152:155], v[136:139], v[64:79]
    v_lshlrev_b32 v6, 3, v6
    v_and_b32 v213, 0xffff0000, v112
    v_lshl_add_u32 v5, v15, 6, v6
    v_add_f32 v210, v210, v212
    v_add_u32 v241, s3, v5
    v_mfma_f32_32x32x16_bf16 v[80:95], v[152:155], v[140:143], v[80:95]
    v_add_f32 v211, v211, v213
    v_add_u32 v6, v4, v11
    v_lshlrev_b32 v214, 16, v113
    v_lshlrev_b32 v6, 3, v6
    v_and_b32 v215, 0xffff0000, v113
    v_mfma_f32_32x32x16_bf16 v[16:31], v[164:167], v[156:159], v[16:31]
    v_lshl_add_u32 v6, v15, 5, v6
    v_add_f32 v210, v210, v214
    v_mov_b32 v5, 0x80
    v_add_f32 v211, v211, v215
    s_bitcmp1_b32 s50, 1
    v_mfma_f32_32x32x16_bf16 v[32:47], v[168:171], v[156:159], v[32:47]
    v_lshlrev_b32 v212, 16, v114
    s_cselect_b64 vcc, -1, 0
    v_and_b32 v213, 0xffff0000, v114
    v_cndmask_b32 v6, v6, v5, vcc
    v_add_f32 v210, v210, v212
    v_mfma_f32_32x32x16_bf16 v[48:63], v[168:171], v[160:163], v[48:63]
    v_add_u32 v242, 133248, v6
    v_add_f32 v211, v211, v213
    v_and_b32 v5, 15, v1
    v_lshlrev_b32 v214, 16, v115
    v_mad_u32_u24 v6, v4, 17, v5
    v_mfma_f32_32x32x16_bf16 v[64:79], v[172:175], v[156:159], v[64:79]
    v_and_b32 v215, 0xffff0000, v115
    s_mul_i32 s3, s81, 68
    v_add_f32 v210, v210, v214
    s_cselect_b32 s81, 16, 0
    v_add_f32 v211, v211, v215
    v_mfma_f32_32x32x16_bf16 v[80:95], v[172:175], v[160:163], v[80:95]
    s_setprio 0
    s_cmp_ge_u32 s50, 4
    s_cbranch_scc1 L_b3
    s_waitcnt vmcnt(7)
    s_barrier
L_b3:
    s_cmp_lg_u32 s50, 0
    s_cbranch_scc1 L_noat
    s_and_b32 s31, s2, 63
    s_lshl_b32 s31, s31, 2
    v_mov_b32 v235, 1
    s_mov_b64 exec, 1
    buffer_atomic_add v235, off, s[24:27], s31 sc1
    s_mov_b64 exec, -1
L_noat:
    ds_read_b128 v[96:99], v176 offset:32768
    s_add_u32 m0, s55, 0
    s_xor_b32 s0, s0, 384
    buffer_load_dwordx4 v200, s[4:7], s0 offen offset:0 lds
    ds_read_b64_tr_b16 v[104:105], v196 offset:20480
    ds_read_b64_tr_b16 v[106:107], v196 offset:20736
    ds_read_b64_tr_b16 v[108:109], v192 offset:20480
    ds_read_b64_tr_b16 v[110:111], v192 offset:20992
    buffer_load_dwordx4 v201, s[4:7], s0 offen offset:1024 lds
    ds_read_b128 v[100:103], v180 offset:32768
    ds_read_b64_tr_b16 v[112:113], v192 offset:21504
    ds_read_b64_tr_b16 v[114:115], v192 offset:22016
    ds_read_b128 v[116:119], v177 offset:32768
    buffer_load_dwordx4 v202, s[4:7], s0 offen offset:2048 lds
    ds_read_b64_tr_b16 v[124:125], v197 offset:20480
    ds_read_b64_tr_b16 v[126:127], v197 offset:20736
    ds_read_b64_tr_b16 v[128:129], v193 offset:20480
    ds_read_b64_tr_b16 v[130:131], v193 offset:20992
    buffer_load_dwordx4 v203, s[4:7], s0 offen offset:3072 lds
    ds_read_b128 v[120:123], v181 offset:32768
    ds_read_b64_tr_b16 v[132:133], v193 offset:21504
    ds_read_b64_tr_b16 v[134:135], v193 offset:22016
    ds_read_b128 v[136:139], v178 offset:32768
    s_add_u32 m0, s56, 0
    s_mul_i32 s1, s0, s54
    s_mul_i32 s63, s0, 1536
    buffer_load_dwordx4 v204, s[8:11], s1 offen lds
    ds_read_b64_tr_b16 v[144:145], v198 offset:20480
    ds_read_b64_tr_b16 v[146:147], v198 offset:20736
    ds_read_b64_tr_b16 v[148:149], v194 offset:20480
    ds_read_b64_tr_b16 v[150:151], v194 offset:20992
    buffer_load_dwordx4 v204, s[12:15], s1 offen offset:1024 lds
    ds_read_b128 v[140:143], v182 offset:32768
    ds_read_b64_tr_b16 v[152:153], v194 offset:21504
    ds_read_b64_tr_b16 v[154:155], v194 offset:22016
    ds_read_b128 v[156:159], v179 offset:32768
    s_mov_b32 exec_hi, 0
    buffer_load_dwordx4 v205, s[16:19], s63 offen offset:2048 lds
    s_mov_b32 exec_hi, -1
    ds_read_b64_tr_b16 v[164:165], v199 offset:20480
    ds_read_b64_tr_b16 v[166:167], v199 offset:20736
    ds_read_b64_tr_b16 v[168:169], v195 offset:20480
    ds_read_b64_tr_b16 v[170:171], v195 offset:20992
    ds_read_b128 v[160:163], v183 offset:32768
    ds_read_b64_tr_b16 v[172:173], v195 offset:21504
    ds_read_b64_tr_b16 v[174:175], v195 offset:22016
    s_waitcnt lgkmcnt(0)
    s_cmp_lt_u32 s50, 4
    s_cbranch_scc1 L_a4
    s_waitcnt vmcnt(7)
    s_barrier
L_a4:
    v_mfma_f32_32x32x16_bf16 v[16:31], v[104:107], v[96:99], v[16:31]
    s_setprio 1
    v_lshlrev_b32 v212, 16, v104
    s_add_u32 s3, s3, s81
    v_and_b32 v213, 0xffff0000, v104
    v_add_u32 v6, s3, v6
    v_add_f32 v206, v206, v212
    v_mfma_f32_32x32x16_bf16 v[32:47], v[108:111], v[96:99], v[32:47]
    v_lshlrev_b32 v6, 4, v6
    v_add_f32 v207, v207, v213
    v_cmp_ne_u32 s[82:83], 0, v5
    v_lshlrev_b32 v214, 16, v105
    s_and_b64 vcc, vcc, s[82:83]
    v_mfma_f32_32x32x16_bf16 v[48:63], v[108:111], v[100:103], v[48:63]
    v_and_b32 v215, 0xffff0000, v105
    v_mov_b32 v5, 2130706432
    v_add_f32 v206, v206, v214
    v_cndmask_b32 v246, v6, v5, vcc
    v_add_f32 v207, v207, v215
    v_mfma_f32_32x32x16_bf16 v[64:79], v[112:115], v[96:99], v[64:79]
    v_min_u32 v15, 16, v8
    v_lshlrev_b32 v212, 16, v106
    v_mad_u32_u24 v15, v9, 17, v15
    v_and_b32 v213, 0xffff0000, v106
    v_lshlrev_b32 v6, 3, v15
    v_mfma_f32_32x32x16_bf16 v[80:95], v[112:115], v[100:103], v[80:95]
    v_add_f32 v206, v206, v212
    v_add_u32 v243, 161792, v6
    v_add_f32 v207, v207, v213
    v_lshlrev_b32 v214, 16, v107
    v_lshlrev_b32 v236, 3, v8
    v_mfma_f32_32x32x16_bf16 v[16:31], v[124:127], v[116:119], v[16:31]
    v_and_b32 v215, 0xffff0000, v107
    v_lshlrev_b32 v238, 2, v1
    v_add_f32 v206, v206, v214
    v_bfe_u32 v15, v8, 2, 1
    v_add_f32 v207, v207, v215
    v_mfma_f32_32x32x16_bf16 v[32:47], v[128:131], v[116:119], v[32:47]
    v_mul_u32_u24 v15, 0x8000, v15
    v_lshlrev_b32 v212, 16, v108
    v_lshl_or_b32 v244, v15, 16, v15
    v_and_b32 v213, 0xffff0000, v108
    v_mfma_f32_32x32x16_bf16 v[48:63], v[128:131], v[120:123], v[48:63]
    v_lshl_add_u32 v13, v9, 2, v10
    v_add_f32 v208, v208, v212
    v_lshlrev_b32 v15, 5, v13
    v_add_f32 v209, v209, v213
    v_lshl_add_u32 v15, v7, 4, v15
    v_mfma_f32_32x32x16_bf16 v[64:79], v[132:135], v[116:119], v[64:79]
    v_lshlrev_b32 v214, 16, v109
    v_lshrrev_b32 v6, 1, v11
    v_and_b32 v215, 0xffff0000, v109
    v_lshl_add_u32 v15, v6, 3, v15
    v_add_f32 v208, v208, v214
    v_mfma_f32_32x32x16_bf16 v[80:95], v[132:135], v[120:123], v[80:95]
    v_add_u32 v245, 163328, v15
    v_add_f32 v209, v209, v215
    v_lshlrev_b32 v212, 16, v110
    v_lshlrev_b32 v5, 7, v13
    v_and_b32 v213, 0xffff0000, v110
    v_mfma_f32_32x32x16_bf16 v[16:31], v[144:147], v[136:139], v[16:31]
    v_lshrrev_b32 v6, 1, v10
    v_add_f32 v208, v208, v212
    v_lshl_add_u32 v5, v6, 6, v5
    v_add_f32 v209, v209, v213
    v_add_u32 v5, v5, v12
    v_mfma_f32_32x32x16_bf16 v[32:47], v[148:151], v[136:139], v[32:47]
    v_lshlrev_b32 v214, 16, v111
    s_lshl_b32 s3, s70, 13
    v_and_b32 v215, 0xffff0000, v111
    v_add_u32 v248, s3, v5
    v_add_f32 v208, v208, v214
    v_mfma_f32_32x32x16_bf16 v[48:63], v[148:151], v[140:143], v[48:63]
    v_xor_b32 v249, 64, v248
    v_add_f32 v209, v209, v215
    v_add_u32 v250, 0x10000, v248
    v_lshlrev_b32 v212, 16, v112
    v_mfma_f32_32x32x16_bf16 v[64:79], v[152:155], v[136:139], v[64:79]
    v_add_u32 v251, 0x10000, v249
    v_and_b32 v213, 0xffff0000, v112
    v_add_u32 v252, 0x20000, v248
    v_add_f32 v210, v210, v212
    v_add_u32 v253, 0x20000, v249
    v_mfma_f32_32x32x16_bf16 v[80:95], v[152:155], v[140:143], v[80:95]
    v_add_f32 v211, v211, v213
    v_lshlrev_b32 v214, 16, v113
    v_lshlrev_b32 v247, 4, v3
    v_and_b32 v215, 0xffff0000, v113
    v_add_u32 v218, 14336, v232
    v_mfma_f32_32x32x16_bf16 v[16:31], v[164:167], v[156:159], v[16:31]
    v_add_f32 v210, v210, v214
    v_lshrrev_b32 v13, 3, v0
    v_add_f32 v211, v211, v215
    v_lshlrev_b32 v254, 10, v13
    v_lshlrev_b32 v212, 16, v114
    v_mfma_f32_32x32x16_bf16 v[32:47], v[168:171], v[156:159], v[32:47]
    v_lshl_add_u32 v254, v3, 4, v254
    v_and_b32 v213, 0xffff0000, v114
    v_lshlrev_b32 v14, 4, v14
    v_add_f32 v210, v210, v212
    v_lshl_add_u32 v14, v2, 10, v14
    v_mfma_f32_32x32x16_bf16 v[48:63], v[168:171], v[160:163], v[48:63]
    v_add_f32 v211, v211, v213
    v_add_u32 v2, 7168, v14
    v_lshlrev_b32 v214, 16, v115
    v_add_u32 v4, 14336, v14
    v_and_b32 v215, 0xffff0000, v115
    v_mfma_f32_32x32x16_bf16 v[64:79], v[172:175], v[156:159], v[64:79]
    v_add_u32 v7, 21504, v14
    v_add_f32 v210, v210, v214
    s_mul_i32 s79, s70, 458752
    v_add_f32 v211, v211, v215
    v_mfma_f32_32x32x16_bf16 v[80:95], v[172:175], v[160:163], v[80:95]
    s_setprio 0
    s_cmp_ge_u32 s50, 4
    s_cbranch_scc1 L_b4
    s_waitcnt vmcnt(7)
    s_barrier
L_b4:
    ds_read_b128 v[96:99], v184 offset:0
    s_add_u32 m0, s55, 32768
    s_xor_b32 s0, s0, 128
    buffer_load_dwordx4 v200, s[4:7], s0 offen offset:0 lds
    ds_read_b64_tr_b16 v[104:105], v196 offset:40960
    ds_read_b64_tr_b16 v[106:107], v196 offset:41216
    ds_read_b64_tr_b16 v[108:109], v192 offset:40960
    ds_read_b64_tr_b16 v[110:111], v192 offset:41472
    buffer_load_dwordx4 v201, s[4:7], s0 offen offset:1024 lds
    ds_read_b128 v[100:103], v188 offset:0
    ds_read_b64_tr_b16 v[112:113], v192 offset:41984
    ds_read_b64_tr_b16 v[114:115], v192 offset:42496
    ds_read_b128 v[116:119], v185 offset:0
    buffer_load_dwordx4 v202, s[4:7], s0 offen offset:2048 lds
    ds_read_b64_tr_b16 v[124:125], v197 offset:40960
    ds_read_b64_tr_b16 v[126:127], v197 offset:41216
    ds_read_b64_tr_b16 v[128:129], v193 offset:40960
    ds_read_b64_tr_b16 v[130:131], v193 offset:41472
    buffer_load_dwordx4 v203, s[4:7], s0 offen offset:3072 lds
    ds_read_b128 v[120:123], v189 offset:0
    ds_read_b64_tr_b16 v[132:133], v193 offset:41984
    ds_read_b64_tr_b16 v[134:135], v193 offset:42496
    ds_read_b128 v[136:139], v186 offset:0
    s_add_u32 m0, s56, 20480
    s_mul_i32 s1, s0, s54
    s_mul_i32 s63, s0, 1536
    buffer_load_dwordx4 v204, s[8:11], s1 offen lds
    ds_read_b64_tr_b16 v[144:145], v198 offset:40960
    ds_read_b64_tr_b16 v[146:147], v198 offset:41216
    ds_read_b64_tr_b16 v[148:149], v194 offset:40960
    ds_read_b64_tr_b16 v[150:151], v194 offset:41472
    buffer_load_dwordx4 v204, s[12:15], s1 offen offset:1024 lds
    ds_read_b128 v[140:143], v190 offset:0
    ds_read_b64_tr_b16 v[152:153], v194 offset:41984
    ds_read_b64_tr_b16 v[154:155], v194 offset:42496
    ds_read_b128 v[156:159], v187 offset:0
    s_mov_b32 exec_hi, 0
    buffer_load_dwordx4 v205, s[16:19], s63 offen offset:2048 lds
    s_mov_b32 exec_hi, -1
    ds_read_b64_tr_b16 v[164:165], v199 offset:40960
    ds_read_b64_tr_b16 v[166:167], v199 offset:41216
    ds_read_b64_tr_b16 v[168:169], v195 offset:40960
    ds_read_b64_tr_b16 v[170:171], v195 offset:41472
    ds_read_b128 v[160:163], v191 offset:0
    ds_read_b64_tr_b16 v[172:173], v195 offset:41984
    ds_read_b64_tr_b16 v[174:175], v195 offset:42496
    s_waitcnt lgkmcnt(0)
    s_cmp_lt_u32 s50, 4
    s_cbranch_scc1 L_a5
    s_waitcnt vmcnt(7)
    s_barrier
L_a5:
    v_mfma_f32_32x32x16_bf16 v[16:31], v[104:107], v[96:99], v[16:31]
    s_setprio 1
    v_lshlrev_b32 v212, 16, v104
    v_and_b32 v213, 0xffff0000, v104
    v_add_f32 v206, v206, v212
    v_mfma_f32_32x32x16_bf16 v[32:47], v[108:111], v[96:99], v[32:47]
    v_add_f32 v207, v207, v213
    v_lshlrev_b32 v214, 16, v105
    v_and_b32 v215, 0xffff0000, v105
    v_mfma_f32_32x32x16_bf16 v[48:63], v[108:111], v[100:103], v[48:63]
    v_add_f32 v206, v206, v214
    v_add_f32 v207, v207, v215
    v_mfma_f32_32x32x16_bf16 v[64:79], v[112:115], v[96:99], v[64:79]
    v_lshlrev_b32 v212, 16, v106
    v_and_b32 v213, 0xffff0000, v106
    v_add_f32 v206, v206, v212
    v_mfma_f32_32x32x16_bf16 v[80:95], v[112:115], v[100:103], v[80:95]
    v_add_f32 v207, v207, v213
    v_lshlrev_b32 v214, 16, v107
    v_mfma_f32_32x32x16_bf16 v[16:31], v[124:127], v[116:119], v[16:31]
    v_and_b32 v215, 0xffff0000, v107
    v_add_f32 v206, v206, v214
    v_add_f32 v207, v207, v215
    v_mfma_f32_32x32x16_bf16 v[32:47], v[128:131], v[116:119], v[32:47]
    v_lshlrev_b32 v212, 16, v108
    v_and_b32 v213, 0xffff0000, v108
    v_mfma_f32_32x32x16_bf16 v[48:63], v[128:131], v[120:123], v[48:63]
    v_add_f32 v208, v208, v212
    v_add_f32 v209, v209, v213
    v_lshlrev_b32 v214, 16, v109
    v_mfma_f32_32x32x16_bf16 v[64:79], v[132:135], v[116:119], v[64:79]
    v_and_b32 v215, 0xffff0000, v109
    v_add_f32 v208, v208, v214
    v_mfma_f32_32x32x16_bf16 v[80:95], v[132:135], v[120:123], v[80:95]
    v_add_f32 v209, v209, v215
    v_lshlrev_b32 v212, 16, v110
    v_and_b32 v213, 0xffff0000, v110
    v_mfma_f32_32x32x16_bf16 v[16:31], v[144:147], v[136:139], v[16:31]
    v_add_f32 v208, v208, v212
    v_add_f32 v209, v209, v213
    v_mfma_f32_32x32x16_bf16 v[32:47], v[148:151], v[136:139], v[32:47]
    v_lshlrev_b32 v214, 16, v111
    v_and_b32 v215, 0xffff0000, v111
    v_add_f32 v208, v208, v214
    v_mfma_f32_32x32x16_bf16 v[48:63], v[148:151], v[140:143], v[48:63]
    v_add_f32 v209, v209, v215
    v_lshlrev_b32 v212, 16, v112
    v_mfma_f32_32x32x16_bf16 v[64:79], v[152:155], v[136:139], v[64:79]
    v_and_b32 v213, 0xffff0000, v112
    v_add_f32 v210, v210, v212
    v_add_f32 v211, v211, v213
    v_mfma_f32_32x32x16_bf16 v[80:95], v[152:155], v[140:143], v[80:95]
    v_lshlrev_b32 v214, 16, v113
    v_and_b32 v215, 0xffff0000, v113
    v_mfma_f32_32x32x16_bf16 v[16:31], v[164:167], v[156:159], v[16:31]
    v_add_f32 v210, v210, v214
    v_add_f32 v211, v211, v215
    v_lshlrev_b32 v212, 16, v114
    v_mfma_f32_32x32x16_bf16 v[32:47], v[168:171], v[156:159], v[32:47]
    v_and_b32 v213, 0xffff0000, v114
    v_add_f32 v210, v210, v212
    v_mfma_f32_32x32x16_bf16 v[48:63], v[168:171], v[160:163], v[48:63]
    v_add_f32 v211, v211, v213
    v_lshlrev_b32 v214, 16, v115
    v_and_b32 v215, 0xffff0000, v115
    v_mfma_f32_32x32x16_bf16 v[64:79], v[172:175], v[156:159], v[64:79]
    v_add_f32 v210, v210, v214
    v_add_f32 v211, v211, v215
    v_mfma_f32_32x32x16_bf16 v[80:95], v[172:175], v[160:163], v[80:95]
    s_setprio 0
    s_cmp_ge_u32 s50, 4
    s_cbranch_scc1 L_b5
    s_waitcnt vmcnt(7)
    s_barrier
L_b5:
    v_mov_b32 v235, 4
    s_cmp_lg_u32 s50, 0
    s_cbranch_scc1 L_nop
    buffer_load_dword v235, v238, s[24:27], 0 offen sc1
L_nop:
    ds_read_b128 v[96:99], v176 offset:0
    s_add_u32 m0, s55, 65536
    s_add_u32 s0, s68, 0
    s_sub_u32 s1, s0, 7
    s_min_u32 s0, s0, s1
    s_lshl_b32 s0, s0, 16
    s_add_u32 s0, s0, s79
    buffer_load_dwordx4 v14, s[32:35], s0 offen offset:0 lds
    ds_read_b64_tr_b16 v[104:105], v196 offset:0
    ds_read_b64_tr_b16 v[106:107], v196 offset:256
    ds_read_b64_tr_b16 v[108:109], v192 offset:0
    ds_read_b64_tr_b16 v[110:111], v192 offset:512
    ds_read_b128 v[100:103], v180 offset:0
    ds_read_b64_tr_b16 v[112:113], v192 offset:1024
    ds_read_b64_tr_b16 v[114:115], v192 offset:1536
    buffer_load_dwordx4 v2, s[32:35], s0 offen offset:1024 lds
    ds_read_b128 v[116:119], v177 offset:0
    ds_read_b64_tr_b16 v[124:125], v197 offset:0
    ds_read_b64_tr_b16 v[126:127], v197 offset:256
    ds_read_b64_tr_b16 v[128:129], v193 offset:0
    ds_read_b64_tr_b16 v[130:131], v193 offset:512
    ds_read_b128 v[120:123], v181 offset:0
    ds_read_b64_tr_b16 v[132:133], v193 offset:1024
    buffer_load_dwordx4 v4, s[32:35], s0 offen offset:2048 lds
    ds_read_b64_tr_b16 v[134:135], v193 offset:1536
    ds_read_b128 v[136:139], v178 offset:0
    ds_read_b64_tr_b16 v[144:145], v198 offset:0
    ds_read_b64_tr_b16 v[146:147], v198 offset:256
    ds_read_b64_tr_b16 v[148:149], v194 offset:0
    ds_read_b64_tr_b16 v[150:151], v194 offset:512
    ds_read_b128 v[140:143], v182 offset:0
    buffer_load_dwordx4 v7, s[32:35], s0 offen offset:3072 lds
    ds_read_b64_tr_b16 v[152:153], v194 offset:1024
    ds_read_b64_tr_b16 v[154:155], v194 offset:1536
    ds_read_b128 v[156:159], v179 offset:0
    ds_read_b64_tr_b16 v[164:165], v199 offset:0
    ds_read_b64_tr_b16 v[166:167], v199 offset:256
    ds_read_b64_tr_b16 v[168:169], v195 offset:0
    ds_read_b64_tr_b16 v[170:171], v195 offset:512
    ds_read_b128 v[160:163], v183 offset:0
    ds_read_b64_tr_b16 v[172:173], v195 offset:1024
    ds_read_b64_tr_b16 v[174:175], v195 offset:1536
    s_waitcnt lgkmcnt(0)
    s_cmp_lt_u32 s50, 4
    s_cbranch_scc1 L_a6
    s_waitcnt vmcnt(4)
    s_barrier
L_a6:
    v_mfma_f32_32x32x16_bf16 v[16:31], v[104:107], v[96:99], v[16:31]
    s_setprio 1
    v_lshlrev_b32 v212, 16, v104
    s_add_u32 s3, s28, 0
    s_sub_u32 s29, s3, 7
    v_and_b32 v213, 0xffff0000, v104
    s_min_u32 s3, s3, s29
    v_add_f32 v206, v206, v212
    v_mfma_f32_32x32x16_bf16 v[32:47], v[108:111], v[96:99], v[32:47]
    s_lshl_b32 s3, s3, 11
    v_add_f32 v207, v207, v213
    s_add_u32 s8, s66, s3
    v_lshlrev_b32 v214, 16, v105
    s_add_u32 s3, s28, 1
    s_sub_u32 s29, s3, 7
    v_mfma_f32_32x32x16_bf16 v[48:63], v[108:111], v[100:103], v[48:63]
    v_and_b32 v215, 0xffff0000, v105
    s_min_u32 s3, s3, s29
    v_add_f32 v206, v206, v214
    s_lshl_b32 s3, s3, 11
    v_add_f32 v207, v207, v215
    s_add_u32 s9, s66, s3
    v_mfma_f32_32x32x16_bf16 v[64:79], v[112:115], v[96:99], v[64:79]
    v_lshlrev_b32 v212, 16, v106
    s_add_u32 s3, s28, 2
    s_sub_u32 s29, s3, 7
    v_and_b32 v213, 0xffff0000, v106
    s_min_u32 s3, s3, s29
    v_mfma_f32_32x32x16_bf16 v[80:95], v[112:115], v[100:103], v[80:95]
    v_add_f32 v206, v206, v212
    s_lshl_b32 s3, s3, 11
    v_add_f32 v207, v207, v213
    s_add_u32 s10, s66, s3
    v_lshlrev_b32 v214, 16, v107
    s_add_u32 s3, s28, 3
    v_mfma_f32_32x32x16_bf16 v[16:31], v[124:127], v[116:119], v[16:31]
    s_sub_u32 s29, s3, 7
    v_and_b32 v215, 0xffff0000, v107
    s_min_u32 s3, s3, s29
    v_add_f32 v206, v206, v214
    s_lshl_b32 s3, s3, 11
    v_add_f32 v207, v207, v215
    v_mfma_f32_32x32x16_bf16 v[32:47], v[128:131], v[116:119], v[32:47]
    s_add_u32 s11, s66, s3
    v_lshlrev_b32 v212, 16, v108
    s_add_u32 s3, s28, 4
    s_sub_u32 s29, s3, 7
    v_and_b32 v213, 0xffff0000, v108
    v_mfma_f32_32x32x16_bf16 v[48:63], v[128:131], v[120:123], v[48:63]
    s_min_u32 s3, s3, s29
    v_add_f32 v208, v208, v212
    s_lshl_b32 s3, s3, 11
    v_add_f32 v209, v209, v213
    s_add_u32 s12, s66, s3
    v_lshlrev_b32 v214, 16, v109
    v_mfma_f32_32x32x16_bf16 v[64:79], v[132:135], v[116:119], v[64:79]
    s_add_u32 s3, s28, 5
    s_sub_u32 s29, s3, 7
    v_and_b32 v215, 0xffff0000, v109
    s_min_u32 s3, s3, s29
    v_add_f32 v208, v208, v214
    s_lshl_b32 s3, s3, 11
    v_mfma_f32_32x32x16_bf16 v[80:95], v[132:135], v[120:123], v[80:95]
    v_add_f32 v209, v209, v215
    s_add_u32 s13, s66, s3
    v_lshlrev_b32 v212, 16, v110
    s_add_u32 s3, s28, 6
    s_sub_u32 s29, s3, 7
    v_mfma_f32_32x32x16_bf16 v[16:31], v[144:147], v[136:139], v[16:31]
    v_and_b32 v213, 0xffff0000, v110
    s_min_u32 s3, s3, s29
    v_add_f32 v208, v208, v212
    s_lshl_b32 s3, s3, 11
    v_add_f32 v209, v209, v213
    s_add_u32 s14, s66, s3
    v_mfma_f32_32x32x16_bf16 v[32:47], v[148:151], v[136:139], v[32:47]
    v_lshlrev_b32 v214, 16, v111
    s_add_u32 s3, s78, 0
    s_and_b32 s3, s3, 3
    v_and_b32 v215, 0xffff0000, v111
    s_add_u32 s3, s3, 7
    v_add_f32 v208, v208, v214
    v_mfma_f32_32x32x16_bf16 v[48:63], v[148:151], v[140:143], v[48:63]
    s_lshl_b32 s3, s3, 11
    v_add_f32 v209, v209, v215
    s_add_u32 s15, s66, s3
    v_lshlrev_b32 v212, 16, v112
    s_add_u32 s3, s78, 1
    v_mfma_f32_32x32x16_bf16 v[64:79], v[152:155], v[136:139], v[64:79]
    s_and_b32 s3, s3, 3
    v_and_b32 v213, 0xffff0000, v112
    s_add_u32 s3, s3, 7
    v_add_f32 v210, v210, v212
    s_lshl_b32 s3, s3, 11
    v_add_f32 v211, v211, v213
    v_mfma_f32_32x32x16_bf16 v[80:95], v[152:155], v[140:143], v[80:95]
    s_add_u32 s16, s66, s3
    v_lshlrev_b32 v214, 16, v113
    s_add_u32 s3, s78, 2
    s_and_b32 s3, s3, 3
    v_and_b32 v215, 0xffff0000, v113
    s_add_u32 s3, s3, 7
    v_mfma_f32_32x32x16_bf16 v[16:31], v[164:167], v[156:159], v[16:31]
    v_add_f32 v210, v210, v214
    s_lshl_b32 s3, s3, 11
    v_add_f32 v211, v211, v215
    s_add_u32 s17, s66, s3
    v_lshlrev_b32 v212, 16, v114
    v_mfma_f32_32x32x16_bf16 v[32:47], v[168:171], v[156:159], v[32:47]
    s_add_u32 s3, s78, 3
    s_and_b32 s3, s3, 3
    v_and_b32 v213, 0xffff0000, v114
    s_add_u32 s3, s3, 7
    v_add_f32 v210, v210, v212
    s_lshl_b32 s3, s3, 11
    v_mfma_f32_32x32x16_bf16 v[48:63], v[168:171], v[160:163], v[48:63]
    v_add_f32 v211, v211, v213
    s_add_u32 s18, s66, s3
    v_lshlrev_b32 v214, 16, v115
    v_mov_b32 v15, 2130706432
    v_cmp_gt_u32 vcc, 8, v1
    v_and_b32 v215, 0xffff0000, v115
    v_mfma_f32_32x32x16_bf16 v[64:79], v[172:175], v[156:159], v[64:79]
    v_cndmask_b32 v247, v15, v247, vcc
    v_add_f32 v210, v210, v214
    v_cmp_eq_u32 vcc, 0, v1
    v_add_f32 v211, v211, v215
    s_nop 0
    v_cndmask_b32 v219, v15, v1, vcc
    v_mfma_f32_32x32x16_bf16 v[80:95], v[172:175], v[160:163], v[80:95]
    s_setprio 0
    s_cmp_ge_u32 s50, 4
    s_cbranch_scc1 L_b6
    s_waitcnt vmcnt(4)
    v_cmp_gt_u32 vcc, 4, v235
    s_cbranch_vccnz L_pspin
L_pok:
    s_barrier
L_b6:
    s_xor_b32 s3, s71, 0x400
    buffer_load_dwordx2 v[224:225], v236, s[20:23], s71 offen sc1
    buffer_load_dwordx2 v[226:227], v236, s[20:23], s3 offen sc1
    ds_read_b128 v[96:99], v176 offset:32768
    s_cmp_ge_u32 s50, 4
    s_cbranch_scc1 L_w10
    s_add_u32 m0, s55, 0
    s_add_u32 s0, s68, 2
    s_sub_u32 s1, s0, 7
    s_min_u32 s0, s0, s1
    s_lshl_b32 s0, s0, 16
    s_add_u32 s0, s0, s79
    buffer_load_dwordx4 v14, s[32:35], s0 offen offset:0 lds
    buffer_load_dwordx4 v2, s[32:35], s0 offen offset:1024 lds
L_w10:
    ds_read_b64_tr_b16 v[104:105], v196 offset:20480
    ds_read_b64_tr_b16 v[106:107], v196 offset:20736
    ds_read_b64_tr_b16 v[108:109], v192 offset:20480
    ds_read_b64_tr_b16 v[110:111], v192 offset:20992
    ds_read_b128 v[100:103], v180 offset:32768
    ds_read_b64_tr_b16 v[112:113], v192 offset:21504
    ds_read_b64_tr_b16 v[114:115], v192 offset:22016
    ds_read_b128 v[116:119], v177 offset:32768
    s_cmp_ge_u32 s50, 4
    s_cbranch_scc1 L_w11
    buffer_load_dwordx4 v4, s[32:35], s0 offen offset:2048 lds
    buffer_load_dwordx4 v7, s[32:35], s0 offen offset:3072 lds
L_w11:
    ds_read_b64_tr_b16 v[124:125], v197 offset:20480
    ds_read_b64_tr_b16 v[126:127], v197 offset:20736
    ds_read_b64_tr_b16 v[128:129], v193 offset:20480
    ds_read_b64_tr_b16 v[130:131], v193 offset:20992
    ds_read_b128 v[120:123], v181 offset:32768
    ds_read_b64_tr_b16 v[132:133], v193 offset:21504
    ds_read_b64_tr_b16 v[134:135], v193 offset:22016
    s_waitcnt lgkmcnt(8)
    v_lshlrev_b32 v212, 16, v104
    ds_read_b128 v[136:139], v178 offset:32768
    v_and_b32 v213, 0xffff0000, v104
    v_add_f32 v206, v206, v212
    s_cmp_ge_u32 s50, 4
    s_cbranch_scc1 L_w12
    s_add_u32 m0, s55, 16384
    s_add_u32 s0, s68, 2
    s_sub_u32 s1, s0, 7
    s_min_u32 s0, s0, s1
    s_lshl_b32 s0, s0, 16
    s_add_u32 s0, s0, s79
    s_add_u32 s0, s0, 917504
    buffer_load_dwordx4 v14, s[32:35], s0 offen offset:0 lds
    buffer_load_dwordx4 v2, s[32:35], s0 offen offset:1024 lds
L_w12:
    v_add_f32 v207, v207, v213
    v_lshlrev_b32 v214, 16, v105
    ds_read_b64_tr_b16 v[144:145], v198 offset:20480
    v_and_b32 v215, 0xffff0000, v105
    v_add_f32 v206, v206, v214
    ds_read_b64_tr_b16 v[146:147], v198 offset:20736
    v_add_f32 v207, v207, v215
    v_lshlrev_b32 v212, 16, v106
    ds_read_b64_tr_b16 v[148:149], v194 offset:20480
    v_and_b32 v213, 0xffff0000, v106
    v_add_f32 v206, v206, v212
    v_add_f32 v207, v207, v213
    ds_read_b64_tr_b16 v[150:151], v194 offset:20992
    v_lshlrev_b32 v214, 16, v107
    v_and_b32 v215, 0xffff0000, v107
    ds_read_b128 v[140:143], v182 offset:32768
    v_add_f32 v206, v206, v214
    v_add_f32 v207, v207, v215
    ds_read_b64_tr_b16 v[152:153], v194 offset:21504
    v_lshlrev_b32 v212, 16, v108
    v_and_b32 v213, 0xffff0000, v108
    ds_read_b64_tr_b16 v[154:155], v194 offset:22016
    v_add_f32 v208, v208, v212
    v_add_f32 v209, v209, v213
    v_lshlrev_b32 v214, 16, v109
    ds_read_b128 v[156:159], v179 offset:32768
    v_and_b32 v215, 0xffff0000, v109
    v_add_f32 v208, v208, v214
    s_cmp_ge_u32 s50, 4
    s_cbranch_scc1 L_w13
    buffer_load_dwordx4 v4, s[32:35], s0 offen offset:2048 lds
    buffer_load_dwordx4 v7, s[32:35], s0 offen offset:3072 lds
L_w13:
    v_add_f32 v209, v209, v215
    v_lshlrev_b32 v212, 16, v110
    ds_read_b64_tr_b16 v[164:165], v199 offset:20480
    v_and_b32 v213, 0xffff0000, v110
    v_add_f32 v208, v208, v212
    ds_read_b64_tr_b16 v[166:167], v199 offset:20736
    v_add_f32 v209, v209, v213
    v_lshlrev_b32 v214, 16, v111
    ds_read_b64_tr_b16 v[168:169], v195 offset:20480
    v_and_b32 v215, 0xffff0000, v111
    v_add_f32 v208, v208, v214
    v_add_f32 v209, v209, v215
    ds_read_b64_tr_b16 v[170:171], v195 offset:20992
    v_lshlrev_b32 v212, 16, v112
    v_and_b32 v213, 0xffff0000, v112
    ds_read_b128 v[160:163], v183 offset:32768
    v_add_f32 v210, v210, v212
    v_add_f32 v211, v211, v213
    ds_read_b64_tr_b16 v[172:173], v195 offset:21504
    v_lshlrev_b32 v214, 16, v113
    v_and_b32 v215, 0xffff0000, v113
    ds_read_b64_tr_b16 v[174:175], v195 offset:22016
    v_add_f32 v210, v210, v214
    v_add_f32 v211, v211, v215
    v_lshlrev_b32 v212, 16, v114
    v_and_b32 v213, 0xffff0000, v114
    v_add_f32 v210, v210, v212
    v_add_f32 v211, v211, v213
    v_lshlrev_b32 v214, 16, v115
    v_and_b32 v215, 0xffff0000, v115
    v_add_f32 v210, v210, v214
    v_add_f32 v211, v211, v215
    v_add_f32 v206, v206, v207
    v_cvt_pk_bf16_f32 v207, v206, v206
    v_lshlrev_b32 v207, 16, v207
    v_sub_f32 v206, v206, v207
    v_cvt_pk_bf16_f32 v206, v207, v206
    ds_write_b32 v233, v206
    v_lshl_add_u32 v233, s53, 10, v233
    v_add_f32 v208, v208, v209
    v_cvt_pk_bf16_f32 v209, v208, v208
    v_lshlrev_b32 v209, 16, v209
    v_sub_f32 v208, v208, v209
    v_cvt_pk_bf16_f32 v208, v209, v208
    ds_write_b32 v233, v208 offset:1024
    v_add_f32 v210, v210, v211
    v_cvt_pk_bf16_f32 v211, v210, v210
    v_lshlrev_b32 v211, 16, v211
    v_sub_f32 v210, v210, v211
    v_cvt_pk_bf16_f32 v210, v211, v210
    ds_write_b32 v233, v210 offset:3072
    s_waitcnt lgkmcnt(0)
    s_cmp_ge_u32 s50, 4
    s_cbranch_scc1 L_B
    s_add_u32 m0, s55, 98304
    s_add_u32 s0, s68, 6
    s_sub_u32 s1, s0, 7
    s_min_u32 s0, s0, s1
    s_lshl_b32 s0, s0, 16
    s_add_u32 s0, s0, s79
    s_add_u32 s0, s0, s67
    buffer_load_dwordx4 v14, s[32:35], s0 offen offset:0 lds
    buffer_load_dwordx4 v2, s[32:35], s0 offen offset:1024 lds
    buffer_load_dwordx4 v4, s[32:35], s0 offen offset:2048 lds
    buffer_load_dwordx4 v7, s[32:35], s0 offen offset:3072 lds
    v_mfma_f32_32x32x16_bf16 v[16:31], v[104:107], v[96:99], v[16:31]
    s_setprio 1
    v_mfma_f32_32x32x16_bf16 v[32:47], v[108:111], v[96:99], v[32:47]
    v_mfma_f32_32x32x16_bf16 v[48:63], v[108:111], v[100:103], v[48:63]
    v_mfma_f32_32x32x16_bf16 v[64:79], v[112:115], v[96:99], v[64:79]
    v_mfma_f32_32x32x16_bf16 v[80:95], v[112:115], v[100:103], v[80:95]
    v_mfma_f32_32x32x16_bf16 v[16:31], v[124:127], v[116:119], v[16:31]
    v_mfma_f32_32x32x16_bf16 v[32:47], v[128:131], v[116:119], v[32:47]
    v_mfma_f32_32x32x16_bf16 v[48:63], v[128:131], v[120:123], v[48:63]
    v_mfma_f32_32x32x16_bf16 v[64:79], v[132:135], v[116:119], v[64:79]
    v_mfma_f32_32x32x16_bf16 v[80:95], v[132:135], v[120:123], v[80:95]
    v_mfma_f32_32x32x16_bf16 v[16:31], v[144:147], v[136:139], v[16:31]
    v_mfma_f32_32x32x16_bf16 v[32:47], v[148:151], v[136:139], v[32:47]
    v_mfma_f32_32x32x16_bf16 v[48:63], v[148:151], v[140:143], v[48:63]
    v_mfma_f32_32x32x16_bf16 v[64:79], v[152:155], v[136:139], v[64:79]
    v_mfma_f32_32x32x16_bf16 v[80:95], v[152:155], v[140:143], v[80:95]
    v_mfma_f32_32x32x16_bf16 v[16:31], v[164:167], v[156:159], v[16:31]
    v_mfma_f32_32x32x16_bf16 v[32:47], v[168:171], v[156:159], v[32:47]
    v_mfma_f32_32x32x16_bf16 v[48:63], v[168:171], v[160:163], v[48:63]
    v_mfma_f32_32x32x16_bf16 v[64:79], v[172:175], v[156:159], v[64:79]
    v_mfma_f32_32x32x16_bf16 v[80:95], v[172:175], v[160:163], v[80:95]
    s_waitcnt vmcnt(4)
    s_barrier
    s_setprio 2
    ds_read_b128 v[176:179], v234
    v_lshl_add_u32 v234, s53, 10, v234
    ds_read_b128 v[180:183], v234 offset:1024
    ds_read_b128 v[184:187], v234 offset:3072
    ds_read_b64_tr_b16 v[220:221], v245
    ds_read_b64_tr_b16 v[222:223], v245 offset:256
    v_mov_b32 v188, v224
    v_mov_b32 v189, v224
    v_mov_b32 v190, v224
    v_mov_b32 v191, v224
    v_mov_b32 v192, v226
    v_mov_b32 v193, v226
    v_mov_b32 v194, v226
    v_mov_b32 v195, v226
    v_mov_b32 v224, v225
    v_mov_b32 v226, v227
    s_waitcnt lgkmcnt(0)
    v_mfma_f32_32x32x16_bf16 v[32:47], v[180:183], v[188:191], v[32:47]
    v_xor_b32 v220, v244, v220
    v_mfma_f32_32x32x16_bf16 v[64:79], v[184:187], v[188:191], v[64:79]
    v_xor_b32 v221, v244, v221
    v_mfma_f32_32x32x16_bf16 v[48:63], v[180:183], v[192:195], v[48:63]
    v_xor_b32 v222, v244, v222
    v_mfma_f32_32x32x16_bf16 v[80:95], v[184:187], v[192:195], v[80:95]
    v_xor_b32 v223, v244, v223
    v_mfma_f32_32x32x16_bf16 v[16:31], v[176:179], v[188:191], v[16:31]
    s_cmp_eq_u32 s51, 1
    s_cbranch_scc1 L_qstA
    v_mul_f32 v196, 0xc0135761, v225
    v_mul_f32 v194, v225, v225
    v_mov_b32 v197, v196
    v_mul_f32 v192, 0x3d372713, v194
    v_rcp_f32 v194, v194
    v_mul_f32 v192, v192, v196
    v_mov_b32 v195, v194
    v_mov_b32 v193, v192
    v_mul_f32 v176, v32, v32
    v_mul_f32 v177, v33, v33
    v_mul_f32 v178, v34, v34
    v_mul_f32 v179, v35, v35
    v_mul_f32 v180, v36, v36
    v_mul_f32 v181, v37, v37
    v_mul_f32 v182, v38, v38
    v_mul_f32 v183, v39, v39
    v_mul_f32 v184, v40, v40
    v_mul_f32 v185, v41, v41
    v_mul_f32 v186, v42, v42
    v_mul_f32 v187, v43, v43
    v_mul_f32 v188, v44, v44
    v_mul_f32 v189, v45, v45
    v_mul_f32 v190, v46, v46
    v_mul_f32 v191, v47, v47
    v_fma_f32 v176, v176, v192, v196
    v_fma_f32 v177, v177, v193, v197
    v_fma_f32 v178, v178, v192, v196
    v_fma_f32 v179, v179, v193, v197
    v_fma_f32 v180, v180, v192, v196
    v_fma_f32 v181, v181, v193, v197
    v_fma_f32 v182, v182, v192, v196
    v_fma_f32 v183, v183, v193, v197
    v_fma_f32 v184, v184, v192, v196
    v_fma_f32 v185, v185, v193, v197
    v_fma_f32 v186, v186, v192, v196
    v_fma_f32 v187, v187, v193, v197
    v_fma_f32 v188, v188, v192, v196
    v_fma_f32 v189, v189, v193, v197
    v_fma_f32 v190, v190, v192, v196
    v_fma_f32 v191, v191, v193, v197
    v_mul_f32 v176, v176, v32
    v_mul_f32 v177, v177, v33
    v_mul_f32 v178, v178, v34
    v_mul_f32 v179, v179, v35
    v_mul_f32 v180, v180, v36
    v_mul_f32 v181, v181, v37
    v_mul_f32 v182, v182, v38
    v_mul_f32 v183, v183, v39
    v_mul_f32 v184, v184, v40
    v_mul_f32 v185, v185, v41
    v_mul_f32 v186, v186, v42
    v_mul_f32 v187, v187, v43
    v_mul_f32 v188, v188, v44
    v_mul_f32 v189, v189, v45
    v_mul_f32 v190, v190, v46
    v_mul_f32 v191, v191, v47
    v_exp_f32 v176, v176
    v_exp_f32 v177, v177
    v_exp_f32 v178, v178
    v_exp_f32 v179, v179
    v_exp_f32 v180, v180
    v_exp_f32 v181, v181
    v_exp_f32 v182, v182
    v_exp_f32 v183, v183
    v_exp_f32 v184, v184
    v_exp_f32 v185, v185
    v_exp_f32 v186, v186
    v_exp_f32 v187, v187
    v_exp_f32 v188, v188
    v_exp_f32 v189, v189
    v_exp_f32 v190, v190
    v_exp_f32 v191, v191
    v_fma_f32 v176, v176, v194, v194
    v_fma_f32 v177, v177, v195, v195
    v_fma_f32 v178, v178, v194, v194
    v_fma_f32 v179, v179, v195, v195
    v_fma_f32 v180, v180, v194, v194
    v_fma_f32 v181, v181, v195, v195
    v_fma_f32 v182, v182, v194, v194
    v_fma_f32 v183, v183, v195, v195
    v_fma_f32 v184, v184, v194, v194
    v_fma_f32 v185, v185, v195, v195
    v_fma_f32 v186, v186, v194, v194
    v_fma_f32 v187, v187, v195, v195
    v_fma_f32 v188, v188, v194, v194
    v_fma_f32 v189, v189, v195, v195
    v_fma_f32 v190, v190, v194, v194
    v_fma_f32 v191, v191, v195, v195
    v_rcp_f32 v176, v176
    v_rcp_f32 v177, v177
    v_rcp_f32 v178, v178
    v_rcp_f32 v179, v179
    v_rcp_f32 v180, v180
    v_rcp_f32 v181, v181
    v_rcp_f32 v182, v182
    v_rcp_f32 v183, v183
    v_rcp_f32 v184, v184
    v_rcp_f32 v185, v185
    v_rcp_f32 v186, v186
    v_rcp_f32 v187, v187
    v_rcp_f32 v188, v188
    v_rcp_f32 v189, v189
    v_rcp_f32 v190, v190
    v_rcp_f32 v191, v191
    v_mul_f32 v32, v32, v64
    v_mul_f32 v33, v33, v65
    v_mul_f32 v34, v34, v66
    v_mul_f32 v35, v35, v67
    v_mul_f32 v36, v36, v68
    v_mul_f32 v37, v37, v69
    v_mul_f32 v38, v38, v70
    v_mul_f32 v39, v39, v71
    v_mul_f32 v40, v40, v72
    v_mul_f32 v41, v41, v73
    v_mul_f32 v42, v42, v74
    v_mul_f32 v43, v43, v75
    v_mul_f32 v44, v44, v76
    v_mul_f32 v45, v45, v77
    v_mul_f32 v46, v46, v78
    v_mul_f32 v47, v47, v79
    v_mul_f32 v32, v32, v176
    v_mul_f32 v33, v33, v177
    v_mul_f32 v34, v34, v178
    v_mul_f32 v35, v35, v179
    v_mul_f32 v36, v36, v180
    v_mul_f32 v37, v37, v181
    v_mul_f32 v38, v38, v182
    v_mul_f32 v39, v39, v183
    v_mul_f32 v40, v40, v184
    v_mul_f32 v41, v41, v185
    v_mul_f32 v42, v42, v186
    v_mul_f32 v43, v43, v187
    v_mul_f32 v44, v44, v188
    v_mul_f32 v45, v45, v189
    v_mul_f32 v46, v46, v190
    v_mul_f32 v47, v47, v191
    v_cvt_pk_bf16_f32 v32, v32, v33
    v_cvt_pk_bf16_f32 v33, v34, v35
    v_cvt_pk_bf16_f32 v34, v36, v37
    v_cvt_pk_bf16_f32 v35, v38, v39
    v_cvt_pk_bf16_f32 v36, v40, v41
    v_cvt_pk_bf16_f32 v37, v42, v43
    v_cvt_pk_bf16_f32 v38, v44, v45
    v_cvt_pk_bf16_f32 v39, v46, v47
    buffer_store_dwordx4 v[32:35], v232, s[20:23], s57 offen sc1
    buffer_store_dwordx4 v[36:39], v232, s[20:23], s57 offen offset:1024 sc1
    v_mul_f32 v196, 0xc0135761, v227
    v_mul_f32 v194, v227, v227
    v_mov_b32 v197, v196
    v_mul_f32 v192, 0x3d372713, v194
    v_rcp_f32 v194, v194
    v_mul_f32 v192, v192, v196
    v_mov_b32 v195, v194
    v_mov_b32 v193, v192
    v_pk_mul_f32 v[176:177], v[48:49], v[48:49]
    v_pk_mul_f32 v[178:179], v[50:51], v[50:51]
    v_pk_mul_f32 v[180:181], v[52:53], v[52:53]
    v_pk_mul_f32 v[182:183], v[54:55], v[54:55]
    v_pk_mul_f32 v[184:185], v[56:57], v[56:57]
    v_pk_mul_f32 v[186:187], v[58:59], v[58:59]
    v_pk_mul_f32 v[188:189], v[60:61], v[60:61]
    v_pk_mul_f32 v[190:191], v[62:63], v[62:63]
    v_pk_fma_f32 v[176:177], v[176:177], v[192:193], v[196:197]
    v_pk_fma_f32 v[178:179], v[178:179], v[192:193], v[196:197]
    v_pk_fma_f32 v[180:181], v[180:181], v[192:193], v[196:197]
    v_pk_fma_f32 v[182:183], v[182:183], v[192:193], v[196:197]
    v_pk_fma_f32 v[184:185], v[184:185], v[192:193], v[196:197]
    v_pk_fma_f32 v[186:187], v[186:187], v[192:193], v[196:197]
    v_pk_fma_f32 v[188:189], v[188:189], v[192:193], v[196:197]
    v_pk_fma_f32 v[190:191], v[190:191], v[192:193], v[196:197]
    v_pk_mul_f32 v[176:177], v[176:177], v[48:49]
    v_pk_mul_f32 v[178:179], v[178:179], v[50:51]
    v_pk_mul_f32 v[180:181], v[180:181], v[52:53]
    v_pk_mul_f32 v[182:183], v[182:183], v[54:55]
    v_pk_mul_f32 v[184:185], v[184:185], v[56:57]
    v_pk_mul_f32 v[186:187], v[186:187], v[58:59]
    v_pk_mul_f32 v[188:189], v[188:189], v[60:61]
    v_pk_mul_f32 v[190:191], v[190:191], v[62:63]
    v_exp_f32 v176, v176
    v_exp_f32 v177, v177
    v_exp_f32 v178, v178
    v_exp_f32 v179, v179
    v_exp_f32 v180, v180
    v_exp_f32 v181, v181
    v_exp_f32 v182, v182
    v_exp_f32 v183, v183
    v_exp_f32 v184, v184
    v_exp_f32 v185, v185
    v_exp_f32 v186, v186
    v_exp_f32 v187, v187
    v_exp_f32 v188, v188
    v_exp_f32 v189, v189
    v_exp_f32 v190, v190
    v_exp_f32 v191, v191
    v_pk_fma_f32 v[176:177], v[176:177], v[194:195], v[194:195]
    v_pk_fma_f32 v[178:179], v[178:179], v[194:195], v[194:195]
    v_pk_fma_f32 v[180:181], v[180:181], v[194:195], v[194:195]
    v_pk_fma_f32 v[182:183], v[182:183], v[194:195], v[194:195]
    v_pk_fma_f32 v[184:185], v[184:185], v[194:195], v[194:195]
    v_pk_fma_f32 v[186:187], v[186:187], v[194:195], v[194:195]
    v_pk_fma_f32 v[188:189], v[188:189], v[194:195], v[194:195]
    v_pk_fma_f32 v[190:191], v[190:191], v[194:195], v[194:195]
    v_rcp_f32 v176, v176
    v_rcp_f32 v177, v177
    v_rcp_f32 v178, v178
    v_rcp_f32 v179, v179
    v_rcp_f32 v180, v180
    v_rcp_f32 v181, v181
    v_rcp_f32 v182, v182
    v_rcp_f32 v183, v183
    v_rcp_f32 v184, v184
    v_rcp_f32 v185, v185
    v_rcp_f32 v186, v186
    v_rcp_f32 v187, v187
    v_rcp_f32 v188, v188
    v_rcp_f32 v189, v189
    v_rcp_f32 v190, v190
    v_rcp_f32 v191, v191
    v_pk_mul_f32 v[48:49], v[48:49], v[80:81]
    v_pk_mul_f32 v[50:51], v[50:51], v[82:83]
    v_pk_mul_f32 v[52:53], v[52:53], v[84:85]
    v_pk_mul_f32 v[54:55], v[54:55], v[86:87]
    v_pk_mul_f32 v[56:57], v[56:57], v[88:89]
    v_pk_mul_f32 v[58:59], v[58:59], v[90:91]
    v_pk_mul_f32 v[60:61], v[60:61], v[92:93]
    v_pk_mul_f32 v[62:63], v[62:63], v[94:95]
    v_pk_mul_f32 v[48:49], v[48:49], v[176:177]
    v_pk_mul_f32 v[50:51], v[50:51], v[178:179]
    v_pk_mul_f32 v[52:53], v[52:53], v[180:181]
    v_pk_mul_f32 v[54:55], v[54:55], v[182:183]
    v_pk_mul_f32 v[56:57], v[56:57], v[184:185]
    v_pk_mul_f32 v[58:59], v[58:59], v[186:187]
    v_pk_mul_f32 v[60:61], v[60:61], v[188:189]
    v_pk_mul_f32 v[62:63], v[62:63], v[190:191]
    v_cvt_pk_bf16_f32 v48, v48, v49
    v_cvt_pk_bf16_f32 v49, v50, v51
    v_cvt_pk_bf16_f32 v50, v52, v53
    v_cvt_pk_bf16_f32 v51, v54, v55
    v_cvt_pk_bf16_f32 v52, v56, v57
    v_cvt_pk_bf16_f32 v53, v58, v59
    v_cvt_pk_bf16_f32 v54, v60, v61
    v_cvt_pk_bf16_f32 v55, v62, v63
    buffer_store_dwordx4 v[48:51], v232, s[20:23], s58 offen sc1
    buffer_store_dwordx4 v[52:55], v232, s[20:23], s58 offen offset:1024 sc1
L_kvA:
    s_setprio 0
    buffer_load_dwordx4 v[228:231], v232, s[20:23], s59 offen sc1
    v_pk_mul_f32 v[16:17], v[16:17], v[224:225]
    v_pk_mul_f32 v[18:19], v[18:19], v[224:225]
    v_pk_mul_f32 v[20:21], v[20:21], v[224:225]
    v_pk_mul_f32 v[22:23], v[22:23], v[224:225]
    v_pk_mul_f32 v[24:25], v[24:25], v[224:225]
    v_pk_mul_f32 v[26:27], v[26:27], v[224:225]
    v_pk_mul_f32 v[28:29], v[28:29], v[224:225]
    v_pk_mul_f32 v[30:31], v[30:31], v[224:225]
    v_cvt_pk_bf16_f32 v96, v16, v17
    v_cvt_pk_bf16_f32 v97, v18, v19
    v_cvt_pk_bf16_f32 v98, v20, v21
    v_cvt_pk_bf16_f32 v99, v22, v23
    v_cvt_pk_bf16_f32 v100, v24, v25
    v_cvt_pk_bf16_f32 v101, v26, v27
    v_cvt_pk_bf16_f32 v102, v28, v29
    v_cvt_pk_bf16_f32 v103, v30, v31
    v_mfma_f32_32x32x16_bf16 v[176:191], v[220:223], v[96:99], 0
    ds_write2_b64 v240, v[100:101], v[102:103] offset0:0 offset1:2
    s_mul_i32 s3, s50, 3328
    s_add_u32 s3, s3, 133376
    v_mul_u32_u24 v15, 136, v1
    v_add_u32 v15, s3, v15
    v_mov_b32 v10, 0x3f803f80
    v_mov_b32 v11, 0x3f803f80
    s_mov_b64 exec, 0xff
    ds_write_b64 v15, v[10:11]
    s_mov_b64 exec, -1
    s_nop 1
    v_max3_f32 v208, v176, v177, v178
    ds_read_b64_tr_b16 v[112:113], v250 offset:0
    v_max3_f32 v209, v179, v180, v181
    ds_read_b64_tr_b16 v[114:115], v250 offset:1024
    v_max3_f32 v210, v182, v183, v184
    v_max3_f32 v211, v185, v186, v187
    ds_read_b64_tr_b16 v[116:117], v251 offset:0
    v_max3_f32 v208, v208, v188, v189
    ds_read_b64_tr_b16 v[118:119], v251 offset:1024
    v_max3_f32 v209, v209, v190, v191
    v_max3_f32 v208, v208, v210, v211
    ds_read_b64_tr_b16 v[120:121], v250 offset:2048
    v_max_f32 v208, v208, v209
    ds_read_b64_tr_b16 v[122:123], v250 offset:3072
    v_mul_f32 v209, 0xbfb8aa3b, v208
    v_mul_f32 v208, 0xbfb8aa3b, v208
    ds_read_b64_tr_b16 v[124:125], v251 offset:2048
    v_pk_fma_f32 v[176:177], v[176:177], s[72:73], v[208:209]
    ds_read_b64_tr_b16 v[126:127], v251 offset:3072
    v_pk_fma_f32 v[178:179], v[178:179], s[72:73], v[208:209]
    v_pk_fma_f32 v[180:181], v[180:181], s[72:73], v[208:209]
    ds_read_b64_tr_b16 v[128:129], v250 offset:4096
    v_pk_fma_f32 v[182:183], v[182:183], s[72:73], v[208:209]
    v_pk_fma_f32 v[184:185], v[184:185], s[72:73], v[208:209]
    ds_read_b64_tr_b16 v[130:131], v250 offset:5120
    v_pk_fma_f32 v[186:187], v[186:187], s[72:73], v[208:209]
    ds_read_b64_tr_b16 v[132:133], v251 offset:4096
    v_pk_fma_f32 v[188:189], v[188:189], s[72:73], v[208:209]
    v_pk_fma_f32 v[190:191], v[190:191], s[72:73], v[208:209]
    ds_read_b64_tr_b16 v[134:135], v251 offset:5120
    v_exp_f32 v176, v176
    ds_read_b64_tr_b16 v[136:137], v250 offset:6144
    v_exp_f32 v177, v177
    v_exp_f32 v178, v178
    ds_read_b64_tr_b16 v[138:139], v250 offset:7168
    v_exp_f32 v179, v179
    ds_read_b64_tr_b16 v[140:141], v251 offset:6144
    v_exp_f32 v180, v180
    v_exp_f32 v181, v181
    ds_read_b64_tr_b16 v[142:143], v251 offset:7168
    v_exp_f32 v182, v182
    v_exp_f32 v183, v183
    ds_read_b64_tr_b16 v[144:145], v248 offset:0
    v_exp_f32 v184, v184
    ds_read_b64_tr_b16 v[146:147], v248 offset:1024
    v_exp_f32 v185, v185
    v_exp_f32 v186, v186
    ds_read_b64_tr_b16 v[148:149], v249 offset:0
    v_exp_f32 v187, v187
    ds_read_b64_tr_b16 v[150:151], v249 offset:1024
    v_exp_f32 v188, v188
    v_exp_f32 v189, v189
    ds_read_b64_tr_b16 v[152:153], v248 offset:2048
    v_exp_f32 v190, v190
    ds_read_b64_tr_b16 v[154:155], v248 offset:3072
    v_exp_f32 v191, v191
    v_pk_add_f32 v[210:211], v[176:177], v[178:179]
    ds_read_b64_tr_b16 v[156:157], v249 offset:2048
    v_pk_add_f32 v[212:213], v[180:181], v[182:183]
    ds_read_b64_tr_b16 v[158:159], v249 offset:3072
    v_pk_add_f32 v[214:215], v[184:185], v[186:187]
    v_pk_add_f32 v[216:217], v[188:189], v[190:191]
    ds_read_b64_tr_b16 v[160:161], v248 offset:4096
    v_pk_add_f32 v[210:211], v[210:211], v[212:213]
    v_pk_add_f32 v[214:215], v[214:215], v[216:217]
    ds_read_b64_tr_b16 v[162:163], v248 offset:5120
    v_pk_add_f32 v[210:211], v[210:211], v[214:215]
    ds_read_b64_tr_b16 v[164:165], v249 offset:4096
    v_add_f32 v208, v210, v211
    v_rcp_f32 v208, v208
    ds_read_b64_tr_b16 v[166:167], v249 offset:5120
    v_mov_b32 v209, v208
    ds_read_b64_tr_b16 v[168:169], v248 offset:6144
    v_pk_mul_f32 v[176:177], v[176:177], v[208:209]
    v_pk_mul_f32 v[178:179], v[178:179], v[208:209]
    ds_read_b64_tr_b16 v[170:171], v248 offset:7168
    v_pk_mul_f32 v[180:181], v[180:181], v[208:209]
    ds_read_b64_tr_b16 v[172:173], v249 offset:6144
    v_pk_mul_f32 v[182:183], v[182:183], v[208:209]
    v_pk_mul_f32 v[184:185], v[184:185], v[208:209]
    ds_read_b64_tr_b16 v[174:175], v249 offset:7168
    v_pk_mul_f32 v[186:187], v[186:187], v[208:209]
    v_pk_mul_f32 v[188:189], v[188:189], v[208:209]
    v_pk_mul_f32 v[190:191], v[190:191], v[208:209]
    v_cvt_pk_bf16_f32 v104, v176, v177
    v_cvt_pk_bf16_f32 v105, v178, v179
    v_cvt_pk_bf16_f32 v106, v180, v181
    v_cvt_pk_bf16_f32 v107, v182, v183
    v_cvt_pk_bf16_f32 v108, v184, v185
    v_cvt_pk_bf16_f32 v109, v186, v187
    v_cvt_pk_bf16_f32 v110, v188, v189
    v_cvt_pk_bf16_f32 v111, v190, v191
    ds_write2_b64 v239, v[104:105], v[106:107] offset0:0 offset1:2
    ds_write2_b64 v239, v[108:109], v[110:111] offset0:4 offset1:6
    s_waitcnt vmcnt(1)
    s_mov_b64 exec, 1
    buffer_store_dword v232, off, s[20:23], s64 sc1
    s_mov_b64 exec, -1
    s_waitcnt lgkmcnt(0)
    s_barrier
    s_setprio 2
    ds_read_b64_tr_b16 v[176:177], v241 offset:0
    ds_read_b64_tr_b16 v[178:179], v241 offset:1088
    ds_read_b64_tr_b16 v[180:181], v242 offset:0
    ds_read_b64_tr_b16 v[182:183], v242 offset:544
    ds_read_b64_tr_b16 v[184:185], v241 offset:3328
    ds_read_b64_tr_b16 v[186:187], v241 offset:4416
    ds_read_b64_tr_b16 v[188:189], v242 offset:3328
    ds_read_b64_tr_b16 v[190:191], v242 offset:3872
    ds_read_b64_tr_b16 v[192:193], v241 offset:6656
    ds_read_b64_tr_b16 v[194:195], v241 offset:7744
    ds_read_b64_tr_b16 v[196:197], v242 offset:6656
    ds_read_b64_tr_b16 v[198:199], v242 offset:7200
    s_waitcnt lgkmcnt(8)
    v_mfma_f32_16x16x32_bf16 v[16:19], v[176:179], v[180:183], 0
    ds_read_b64_tr_b16 v[176:177], v241 offset:9984
    ds_read_b64_tr_b16 v[178:179], v241 offset:11072
    ds_read_b64_tr_b16 v[180:181], v242 offset:9984
    ds_read_b64_tr_b16 v[182:183], v242 offset:10528
    s_waitcnt lgkmcnt(8)
    v_mfma_f32_16x16x32_bf16 v[16:19], v[184:187], v[188:191], v[16:19]
    ds_read_b64_tr_b16 v[184:185], v241 offset:13312
    ds_read_b64_tr_b16 v[186:187], v241 offset:14400
    ds_read_b64_tr_b16 v[188:189], v242 offset:13312
    ds_read_b64_tr_b16 v[190:191], v242 offset:13856
    s_waitcnt lgkmcnt(8)
    v_mfma_f32_16x16x32_bf16 v[16:19], v[192:195], v[196:199], v[16:19]
    ds_read_b64_tr_b16 v[192:193], v241 offset:16640
    ds_read_b64_tr_b16 v[194:195], v241 offset:17728
    ds_read_b64_tr_b16 v[196:197], v242 offset:16640
    ds_read_b64_tr_b16 v[198:199], v242 offset:17184
    s_waitcnt lgkmcnt(8)
    v_mfma_f32_16x16x32_bf16 v[16:19], v[176:179], v[180:183], v[16:19]
    ds_read_b64_tr_b16 v[176:177], v241 offset:19968
    ds_read_b64_tr_b16 v[178:179], v241 offset:21056
    ds_read_b64_tr_b16 v[180:181], v242 offset:19968
    ds_read_b64_tr_b16 v[182:183], v242 offset:20512
    s_waitcnt lgkmcnt(8)
    v_mfma_f32_16x16x32_bf16 v[16:19], v[184:187], v[188:191], v[16:19]
    ds_read_b64_tr_b16 v[184:185], v241 offset:23296
    ds_read_b64_tr_b16 v[186:187], v241 offset:24384
    ds_read_b64_tr_b16 v[188:189], v242 offset:23296
    ds_read_b64_tr_b16 v[190:191], v242 offset:23840
    s_waitcnt lgkmcnt(8)
    v_mfma_f32_16x16x32_bf16 v[16:19], v[192:195], v[196:199], v[16:19]
    s_waitcnt lgkmcnt(4)
    v_mfma_f32_16x16x32_bf16 v[16:19], v[176:179], v[180:183], v[16:19]
    s_waitcnt lgkmcnt(0)
    v_mfma_f32_16x16x32_bf16 v[16:19], v[184:187], v[188:191], v[16:19]
    s_nop 7
    buffer_store_dwordx4 v[16:19], v246, s[20:23], s60 offen sc1
    s_setprio 0
    buffer_load_dwordx4 v[100:103], v254, s[40:43], 0 offen
    s_add_u32 m0, s55, 65536
    s_add_u32 s0, s68, 1
    s_sub_u32 s1, s0, 7
    s_min_u32 s0, s0, s1
    s_lshl_b32 s0, s0, 16
    s_add_u32 s0, s0, s79
    s_add_u32 s0, s0, 32768
    buffer_load_dwordx4 v14, s[32:35], s0 offen offset:0 lds
    buffer_load_dwordx4 v2, s[32:35], s0 offen offset:1024 lds
    buffer_load_dwordx4 v4, s[32:35], s0 offen offset:2048 lds
    buffer_load_dwordx4 v7, s[32:35], s0 offen offset:3072 lds
    s_add_u32 m0, s55, 81920
    s_add_u32 s0, s68, 1
    s_sub_u32 s1, s0, 7
    s_min_u32 s0, s0, s1
    s_lshl_b32 s0, s0, 16
    s_add_u32 s0, s0, s79
    s_add_u32 s0, s0, 950272
    buffer_load_dwordx4 v14, s[32:35], s0 offen offset:0 lds
    buffer_load_dwordx4 v2, s[32:35], s0 offen offset:1024 lds
    buffer_load_dwordx4 v4, s[32:35], s0 offen offset:2048 lds
    buffer_load_dwordx4 v7, s[32:35], s0 offen offset:3072 lds
    s_barrier
    s_add_u32 m0, s55, 0
    s_add_u32 s0, s68, 3
    s_sub_u32 s1, s0, 7
    s_min_u32 s0, s0, s1
    s_lshl_b32 s0, s0, 16
    s_add_u32 s0, s0, s79
    s_add_u32 s0, s0, 32768
    buffer_load_dwordx4 v14, s[32:35], s0 offen offset:0 lds
    buffer_load_dwordx4 v2, s[32:35], s0 offen offset:1024 lds
    buffer_load_dwordx4 v4, s[32:35], s0 offen offset:2048 lds
    buffer_load_dwordx4 v7, s[32:35], s0 offen offset:3072 lds
    s_add_u32 m0, s55, 16384
    s_add_u32 s0, s68, 3
    s_sub_u32 s1, s0, 7
    s_min_u32 s0, s0, s1
    s_lshl_b32 s0, s0, 16
    s_add_u32 s0, s0, s79
    s_add_u32 s0, s0, 950272
    buffer_load_dwordx4 v14, s[32:35], s0 offen offset:0 lds
    buffer_load_dwordx4 v2, s[32:35], s0 offen offset:1024 lds
    buffer_load_dwordx4 v4, s[32:35], s0 offen offset:2048 lds
    buffer_load_dwordx4 v7, s[32:35], s0 offen offset:3072 lds
    buffer_load_dword v235, v247, s[20:23], s65 offen sc1
    s_add_u32 m0, s55, 131072
    s_add_u32 s0, s68, 5
    s_sub_u32 s1, s0, 7
    s_min_u32 s0, s0, s1
    s_lshl_b32 s0, s0, 16
    s_add_u32 s0, s0, s79
    s_add_u32 s0, s0, 32768
    buffer_load_dwordx4 v14, s[32:35], s0 offen offset:0 lds
    buffer_load_dwordx4 v2, s[32:35], s0 offen offset:1024 lds
    buffer_load_dwordx4 v4, s[32:35], s0 offen offset:2048 lds
    buffer_load_dwordx4 v7, s[32:35], s0 offen offset:3072 lds
    s_add_u32 m0, s55, 147456
    s_add_u32 s0, s68, 5
    s_sub_u32 s1, s0, 7
    s_min_u32 s0, s0, s1
    s_lshl_b32 s0, s0, 16
    s_add_u32 s0, s0, s79
    s_add_u32 s0, s0, 950272
    buffer_load_dwordx4 v14, s[32:35], s0 offen offset:0 lds
    buffer_load_dwordx4 v2, s[32:35], s0 offen offset:1024 lds
    s_cmp_eq_u32 s50, 3
    s_cbranch_scc1 L_no6
    buffer_load_dwordx4 v4, s[32:35], s0 offen offset:2048 lds
    buffer_load_dwordx4 v7, s[32:35], s0 offen offset:3072 lds
L_no6:
    s_waitcnt vmcnt(6)
    s_branch L_join
L_B:
    s_waitcnt vmcnt(2)
    s_barrier
    v_mfma_f32_32x32x16_bf16 v[16:31], v[104:107], v[96:99], v[16:31]
    s_setprio 1
    ds_read_b128 v[176:179], v234
    v_lshl_add_u32 v234, s53, 10, v234
    ds_read_b128 v[180:183], v234 offset:1024
    ds_read_b128 v[184:187], v234 offset:3072
    ds_read_b64_tr_b16 v[220:221], v245
    ds_read_b64_tr_b16 v[222:223], v245 offset:256
    v_mfma_f32_32x32x16_bf16 v[32:47], v[108:111], v[96:99], v[32:47]
    s_add_u32 m0, s55, 32768
    s_add_u32 s0, s68, 4
    s_sub_u32 s1, s0, 7
    s_min_u32 s0, s0, s1
    s_lshl_b32 s0, s0, 16
    s_add_u32 s0, s0, s79
    buffer_load_dwordx4 v14, s[32:35], s0 offen offset:0 lds
    v_mfma_f32_32x32x16_bf16 v[48:63], v[108:111], v[100:103], v[48:63]
    buffer_load_dwordx4 v2, s[32:35], s0 offen offset:1024 lds
    v_mfma_f32_32x32x16_bf16 v[64:79], v[112:115], v[96:99], v[64:79]
    v_mfma_f32_32x32x16_bf16 v[80:95], v[112:115], v[100:103], v[80:95]
    buffer_load_dwordx4 v4, s[32:35], s0 offen offset:2048 lds
    v_mfma_f32_32x32x16_bf16 v[16:31], v[124:127], v[116:119], v[16:31]
    buffer_load_dwordx4 v7, s[32:35], s0 offen offset:3072 lds
    v_mfma_f32_32x32x16_bf16 v[32:47], v[128:131], v[116:119], v[32:47]
    s_add_u32 m0, s55, 16384
    s_add_u32 s0, s68, 4
    s_sub_u32 s1, s0, 7
    s_min_u32 s0, s0, s1
    s_lshl_b32 s0, s0, 16
    s_add_u32 s0, s0, s79
    s_add_u32 s0, s0, 4294049792
    buffer_load_dwordx4 v14, s[32:35], s0 offen offset:0 lds
    v_mfma_f32_32x32x16_bf16 v[48:63], v[128:131], v[120:123], v[48:63]
    v_mfma_f32_32x32x16_bf16 v[64:79], v[132:135], v[116:119], v[64:79]
    buffer_load_dwordx4 v2, s[32:35], s0 offen offset:1024 lds
    v_mfma_f32_32x32x16_bf16 v[80:95], v[132:135], v[120:123], v[80:95]
    buffer_load_dwordx4 v4, s[32:35], s0 offen offset:2048 lds
    v_mfma_f32_32x32x16_bf16 v[16:31], v[144:147], v[136:139], v[16:31]
    buffer_load_dwordx4 v7, s[32:35], s0 offen offset:3072 lds
    v_mfma_f32_32x32x16_bf16 v[32:47], v[148:151], v[136:139], v[32:47]
    v_mfma_f32_32x32x16_bf16 v[48:63], v[148:151], v[140:143], v[48:63]
    s_waitcnt vmcnt(8)
    v_mov_b32 v188, v224
    v_mov_b32 v189, v224
    v_mov_b32 v190, v224
    v_mov_b32 v191, v224
    v_mov_b32 v192, v226
    v_mov_b32 v193, v226
    v_mov_b32 v194, v226
    v_mov_b32 v195, v226
    v_mov_b32 v224, v225
    v_mov_b32 v226, v227
    v_mfma_f32_32x32x16_bf16 v[64:79], v[152:155], v[136:139], v[64:79]
    s_add_u32 m0, s55, 98304
    s_add_u32 s0, s68, 6
    s_sub_u32 s1, s0, 7
    s_min_u32 s0, s0, s1
    s_lshl_b32 s0, s0, 16
    s_add_u32 s0, s0, s79
    s_add_u32 s0, s0, s67
    buffer_load_dwordx4 v14, s[32:35], s0 offen offset:0 lds
    v_mfma_f32_32x32x16_bf16 v[80:95], v[152:155], v[140:143], v[80:95]
    buffer_load_dwordx4 v2, s[32:35], s0 offen offset:1024 lds
    v_mfma_f32_32x32x16_bf16 v[16:31], v[164:167], v[156:159], v[16:31]
    v_mfma_f32_32x32x16_bf16 v[32:47], v[168:171], v[156:159], v[32:47]
    buffer_load_dwordx4 v4, s[32:35], s0 offen offset:2048 lds
    v_mfma_f32_32x32x16_bf16 v[48:63], v[168:171], v[160:163], v[48:63]
    buffer_load_dwordx4 v7, s[32:35], s0 offen offset:3072 lds
    v_mfma_f32_32x32x16_bf16 v[64:79], v[172:175], v[156:159], v[64:79]
    v_mfma_f32_32x32x16_bf16 v[80:95], v[172:175], v[160:163], v[80:95]
    s_waitcnt lgkmcnt(0)
    v_mfma_f32_32x32x16_bf16 v[16:31], v[176:179], v[188:191], v[16:31]
    v_xor_b32 v220, v244, v220
    v_xor_b32 v221, v244, v221
    v_xor_b32 v222, v244, v222
    v_xor_b32 v223, v244, v223
    v_mfma_f32_32x32x16_bf16 v[32:47], v[180:183], v[188:191], v[32:47]
    ds_read_b64_tr_b16 v[112:113], v250 offset:0
    ds_read_b64_tr_b16 v[114:115], v250 offset:1024
    ds_read_b64_tr_b16 v[116:117], v251 offset:0
    ds_read_b64_tr_b16 v[118:119], v251 offset:1024
    v_mfma_f32_32x32x16_bf16 v[64:79], v[184:187], v[188:191], v[64:79]
    ds_read_b64_tr_b16 v[120:121], v250 offset:2048
    ds_read_b64_tr_b16 v[122:123], v250 offset:3072
    ds_read_b64_tr_b16 v[124:125], v251 offset:2048
    ds_read_b64_tr_b16 v[126:127], v251 offset:3072
    v_mfma_f32_32x32x16_bf16 v[48:63], v[180:183], v[192:195], v[48:63]
    ds_read_b64_tr_b16 v[128:129], v250 offset:4096
    ds_read_b64_tr_b16 v[130:131], v250 offset:5120
    ds_read_b64_tr_b16 v[132:133], v251 offset:4096
    ds_read_b64_tr_b16 v[134:135], v251 offset:5120
    v_mfma_f32_32x32x16_bf16 v[80:95], v[184:187], v[192:195], v[80:95]
    ds_read_b64_tr_b16 v[136:137], v250 offset:6144
    ds_read_b64_tr_b16 v[138:139], v250 offset:7168
    ds_read_b64_tr_b16 v[140:141], v251 offset:6144
    ds_read_b64_tr_b16 v[142:143], v251 offset:7168
    s_cmp_eq_u32 s51, 1
    s_cbranch_scc1 L_qstB
L_kvB:
    v_pk_mul_f32 v[16:17], v[16:17], v[224:225]
    v_pk_mul_f32 v[18:19], v[18:19], v[224:225]
    v_pk_mul_f32 v[20:21], v[20:21], v[224:225]
    v_pk_mul_f32 v[22:23], v[22:23], v[224:225]
    v_pk_mul_f32 v[24:25], v[24:25], v[224:225]
    v_pk_mul_f32 v[26:27], v[26:27], v[224:225]
    v_pk_mul_f32 v[28:29], v[28:29], v[224:225]
    v_pk_mul_f32 v[30:31], v[30:31], v[224:225]
    v_cvt_pk_bf16_f32 v96, v16, v17
    v_cvt_pk_bf16_f32 v97, v18, v19
    v_cvt_pk_bf16_f32 v98, v20, v21
    v_cvt_pk_bf16_f32 v99, v22, v23
    v_cvt_pk_bf16_f32 v100, v24, v25
    v_cvt_pk_bf16_f32 v101, v26, v27
    v_cvt_pk_bf16_f32 v102, v28, v29
    v_cvt_pk_bf16_f32 v103, v30, v31
    v_mfma_f32_32x32x16_bf16 v[176:191], v[220:223], v[96:99], 0
    ds_write2_b64 v240, v[100:101], v[102:103] offset0:0 offset1:2
    s_mul_i32 s3, s50, 3328
    s_add_u32 s3, s3, 133376
    v_mul_u32_u24 v15, 136, v1
    v_add_u32 v15, s3, v15
    v_mov_b32 v10, 0x3f803f80
    v_mov_b32 v11, 0x3f803f80
    s_mov_b64 exec, 0xff
    ds_write_b64 v15, v[10:11]
    s_mov_b64 exec, -1
    s_nop 1
    v_max3_f32 v208, v176, v177, v178
    ds_read_b64_tr_b16 v[144:145], v248 offset:0
    v_max3_f32 v209, v179, v180, v181
    v_max3_f32 v210, v182, v183, v184
    v_max3_f32 v211, v185, v186, v187
    ds_read_b64_tr_b16 v[146:147], v248 offset:1024
    v_max3_f32 v208, v208, v188, v189
    v_max3_f32 v209, v209, v190, v191
    v_max3_f32 v208, v208, v210, v211
    ds_read_b64_tr_b16 v[148:149], v249 offset:0
    v_max_f32 v208, v208, v209
    v_mul_f32 v209, 0xbfb8aa3b, v208
    v_mul_f32 v208, 0xbfb8aa3b, v208
    ds_read_b64_tr_b16 v[150:151], v249 offset:1024
    v_pk_fma_f32 v[176:177], v[176:177], s[72:73], v[208:209]
    v_pk_fma_f32 v[178:179], v[178:179], s[72:73], v[208:209]
    v_pk_fma_f32 v[180:181], v[180:181], s[72:73], v[208:209]
    ds_read_b64_tr_b16 v[152:153], v248 offset:2048
    v_pk_fma_f32 v[182:183], v[182:183], s[72:73], v[208:209]
    v_pk_fma_f32 v[184:185], v[184:185], s[72:73], v[208:209]
    v_pk_fma_f32 v[186:187], v[186:187], s[72:73], v[208:209]
    ds_read_b64_tr_b16 v[154:155], v248 offset:3072
    v_pk_fma_f32 v[188:189], v[188:189], s[72:73], v[208:209]
    v_pk_fma_f32 v[190:191], v[190:191], s[72:73], v[208:209]
    v_exp_f32 v176, v176
    ds_read_b64_tr_b16 v[156:157], v249 offset:2048
    v_exp_f32 v177, v177
    v_exp_f32 v178, v178
    v_exp_f32 v179, v179
    ds_read_b64_tr_b16 v[158:159], v249 offset:3072
    v_exp_f32 v180, v180
    v_exp_f32 v181, v181
    v_exp_f32 v182, v182
    v_exp_f32 v183, v183
    ds_read_b64_tr_b16 v[160:161], v248 offset:4096
    v_exp_f32 v184, v184
    v_exp_f32 v185, v185
    v_exp_f32 v186, v186
    ds_read_b64_tr_b16 v[162:163], v248 offset:5120
    v_exp_f32 v187, v187
    v_exp_f32 v188, v188
    v_exp_f32 v189, v189
    ds_read_b64_tr_b16 v[164:165], v249 offset:4096
    v_exp_f32 v190, v190
    v_exp_f32 v191, v191
    v_pk_add_f32 v[210:211], v[176:177], v[178:179]
    ds_read_b64_tr_b16 v[166:167], v249 offset:5120
    v_pk_add_f32 v[212:213], v[180:181], v[182:183]
    v_pk_add_f32 v[214:215], v[184:185], v[186:187]
    v_pk_add_f32 v[216:217], v[188:189], v[190:191]
    ds_read_b64_tr_b16 v[168:169], v248 offset:6144
    v_pk_add_f32 v[210:211], v[210:211], v[212:213]
    v_pk_add_f32 v[214:215], v[214:215], v[216:217]
    v_pk_add_f32 v[210:211], v[210:211], v[214:215]
    ds_read_b64_tr_b16 v[170:171], v248 offset:7168
    v_add_f32 v208, v210, v211
    v_rcp_f32 v208, v208
    s_nop 0
    v_mov_b32 v209, v208
    ds_read_b64_tr_b16 v[172:173], v249 offset:6144
    v_pk_mul_f32 v[176:177], v[176:177], v[208:209]
    v_pk_mul_f32 v[178:179], v[178:179], v[208:209]
    v_pk_mul_f32 v[180:181], v[180:181], v[208:209]
    ds_read_b64_tr_b16 v[174:175], v249 offset:7168
    v_pk_mul_f32 v[182:183], v[182:183], v[208:209]
    v_pk_mul_f32 v[184:185], v[184:185], v[208:209]
    v_pk_mul_f32 v[186:187], v[186:187], v[208:209]
    v_pk_mul_f32 v[188:189], v[188:189], v[208:209]
    v_pk_mul_f32 v[190:191], v[190:191], v[208:209]
    v_cvt_pk_bf16_f32 v104, v176, v177
    v_cvt_pk_bf16_f32 v105, v178, v179
    v_cvt_pk_bf16_f32 v106, v180, v181
    v_cvt_pk_bf16_f32 v107, v182, v183
    v_cvt_pk_bf16_f32 v108, v184, v185
    v_cvt_pk_bf16_f32 v109, v186, v187
    v_cvt_pk_bf16_f32 v110, v188, v189
    v_cvt_pk_bf16_f32 v111, v190, v191
    ds_write2_b64 v239, v[104:105], v[106:107] offset0:0 offset1:2
    ds_write2_b64 v239, v[108:109], v[110:111] offset0:4 offset1:6
    buffer_load_dwordx4 v[228:231], v232, s[20:23], s59 offen sc1
    s_cmp_eq_u32 s51, 1
    s_cbranch_scc1 L_f0B
    v_mul_f32 v196, 0xc0135761, v225
    v_mul_f32 v194, v225, v225
    v_mov_b32 v197, v196
    v_mul_f32 v192, 0x3d372713, v194
    v_rcp_f32 v194, v194
    v_mul_f32 v192, v192, v196
    v_mov_b32 v195, v194
    v_mov_b32 v193, v192
    v_pk_mul_f32 v[176:177], v[32:33], v[32:33]
    v_pk_mul_f32 v[178:179], v[34:35], v[34:35]
    v_pk_mul_f32 v[180:181], v[36:37], v[36:37]
    v_pk_mul_f32 v[182:183], v[38:39], v[38:39]
    v_pk_mul_f32 v[184:185], v[40:41], v[40:41]
    v_pk_mul_f32 v[186:187], v[42:43], v[42:43]
    v_pk_mul_f32 v[188:189], v[44:45], v[44:45]
    v_pk_mul_f32 v[190:191], v[46:47], v[46:47]
    v_pk_fma_f32 v[176:177], v[176:177], v[192:193], v[196:197]
    v_pk_fma_f32 v[178:179], v[178:179], v[192:193], v[196:197]
    v_pk_fma_f32 v[180:181], v[180:181], v[192:193], v[196:197]
    v_pk_fma_f32 v[182:183], v[182:183], v[192:193], v[196:197]
    v_pk_fma_f32 v[184:185], v[184:185], v[192:193], v[196:197]
    v_pk_fma_f32 v[186:187], v[186:187], v[192:193], v[196:197]
    v_pk_fma_f32 v[188:189], v[188:189], v[192:193], v[196:197]
    v_pk_fma_f32 v[190:191], v[190:191], v[192:193], v[196:197]
    v_pk_mul_f32 v[176:177], v[176:177], v[32:33]
    v_pk_mul_f32 v[178:179], v[178:179], v[34:35]
    v_pk_mul_f32 v[180:181], v[180:181], v[36:37]
    v_pk_mul_f32 v[182:183], v[182:183], v[38:39]
    v_pk_mul_f32 v[184:185], v[184:185], v[40:41]
    v_pk_mul_f32 v[186:187], v[186:187], v[42:43]
    v_pk_mul_f32 v[188:189], v[188:189], v[44:45]
    v_pk_mul_f32 v[190:191], v[190:191], v[46:47]
    v_exp_f32 v176, v176
    v_exp_f32 v177, v177
    v_exp_f32 v178, v178
    v_exp_f32 v179, v179
    v_exp_f32 v180, v180
    v_exp_f32 v181, v181
    v_exp_f32 v182, v182
    v_exp_f32 v183, v183
    v_exp_f32 v184, v184
    v_exp_f32 v185, v185
    v_exp_f32 v186, v186
    v_exp_f32 v187, v187
    v_exp_f32 v188, v188
    v_exp_f32 v189, v189
    v_exp_f32 v190, v190
    v_exp_f32 v191, v191
    v_pk_fma_f32 v[176:177], v[176:177], v[194:195], v[194:195]
    v_pk_fma_f32 v[178:179], v[178:179], v[194:195], v[194:195]
    v_pk_fma_f32 v[180:181], v[180:181], v[194:195], v[194:195]
    v_pk_fma_f32 v[182:183], v[182:183], v[194:195], v[194:195]
    v_pk_fma_f32 v[184:185], v[184:185], v[194:195], v[194:195]
    v_pk_fma_f32 v[186:187], v[186:187], v[194:195], v[194:195]
    v_pk_fma_f32 v[188:189], v[188:189], v[194:195], v[194:195]
    v_pk_fma_f32 v[190:191], v[190:191], v[194:195], v[194:195]
    v_rcp_f32 v176, v176
    v_rcp_f32 v177, v177
    v_rcp_f32 v178, v178
    v_rcp_f32 v179, v179
    v_rcp_f32 v180, v180
    v_rcp_f32 v181, v181
    v_rcp_f32 v182, v182
    v_rcp_f32 v183, v183
    v_rcp_f32 v184, v184
    v_rcp_f32 v185, v185
    v_rcp_f32 v186, v186
    v_rcp_f32 v187, v187
    v_rcp_f32 v188, v188
    v_rcp_f32 v189, v189
    v_rcp_f32 v190, v190
    v_rcp_f32 v191, v191
    v_pk_mul_f32 v[32:33], v[32:33], v[64:65]
    v_pk_mul_f32 v[34:35], v[34:35], v[66:67]
    v_pk_mul_f32 v[36:37], v[36:37], v[68:69]
    v_pk_mul_f32 v[38:39], v[38:39], v[70:71]
    v_pk_mul_f32 v[40:41], v[40:41], v[72:73]
    v_pk_mul_f32 v[42:43], v[42:43], v[74:75]
    v_pk_mul_f32 v[44:45], v[44:45], v[76:77]
    v_pk_mul_f32 v[46:47], v[46:47], v[78:79]
    v_pk_mul_f32 v[32:33], v[32:33], v[176:177]
    v_pk_mul_f32 v[34:35], v[34:35], v[178:179]
    v_pk_mul_f32 v[36:37], v[36:37], v[180:181]
    v_pk_mul_f32 v[38:39], v[38:39], v[182:183]
    v_pk_mul_f32 v[40:41], v[40:41], v[184:185]
    v_pk_mul_f32 v[42:43], v[42:43], v[186:187]
    v_pk_mul_f32 v[44:45], v[44:45], v[188:189]
    v_pk_mul_f32 v[46:47], v[46:47], v[190:191]
    v_cvt_pk_bf16_f32 v32, v32, v33
    v_cvt_pk_bf16_f32 v33, v34, v35
    v_cvt_pk_bf16_f32 v34, v36, v37
    v_cvt_pk_bf16_f32 v35, v38, v39
    v_cvt_pk_bf16_f32 v36, v40, v41
    v_cvt_pk_bf16_f32 v37, v42, v43
    v_cvt_pk_bf16_f32 v38, v44, v45
    v_cvt_pk_bf16_f32 v39, v46, v47
    s_waitcnt vmcnt(1)
    buffer_store_dwordx4 v[32:35], v232, s[20:23], s57 offen sc1
    buffer_store_dwordx4 v[36:39], v232, s[20:23], s57 offen offset:1024 sc1
L_g0B:
    s_waitcnt lgkmcnt(0)
    s_barrier
    s_cmp_eq_u32 s51, 1
    s_cbranch_scc1 L_g1B
    v_mul_f32 v196, 0xc0135761, v227
    v_mul_f32 v194, v227, v227
    v_mov_b32 v197, v196
    v_mul_f32 v192, 0x3d372713, v194
    v_rcp_f32 v194, v194
    v_mul_f32 v192, v192, v196
    v_mov_b32 v195, v194
    v_mov_b32 v193, v192
    v_pk_mul_f32 v[176:177], v[48:49], v[48:49]
    v_pk_mul_f32 v[178:179], v[50:51], v[50:51]
    v_pk_mul_f32 v[180:181], v[52:53], v[52:53]
    v_pk_mul_f32 v[182:183], v[54:55], v[54:55]
    v_pk_mul_f32 v[184:185], v[56:57], v[56:57]
    v_pk_mul_f32 v[186:187], v[58:59], v[58:59]
    v_pk_mul_f32 v[188:189], v[60:61], v[60:61]
    v_pk_mul_f32 v[190:191], v[62:63], v[62:63]
    v_pk_fma_f32 v[176:177], v[176:177], v[192:193], v[196:197]
    v_pk_fma_f32 v[178:179], v[178:179], v[192:193], v[196:197]
    v_pk_fma_f32 v[180:181], v[180:181], v[192:193], v[196:197]
    v_pk_fma_f32 v[182:183], v[182:183], v[192:193], v[196:197]
    v_pk_fma_f32 v[184:185], v[184:185], v[192:193], v[196:197]
    v_pk_fma_f32 v[186:187], v[186:187], v[192:193], v[196:197]
    v_pk_fma_f32 v[188:189], v[188:189], v[192:193], v[196:197]
    v_pk_fma_f32 v[190:191], v[190:191], v[192:193], v[196:197]
    v_pk_mul_f32 v[176:177], v[176:177], v[48:49]
    v_pk_mul_f32 v[178:179], v[178:179], v[50:51]
    v_pk_mul_f32 v[180:181], v[180:181], v[52:53]
    v_pk_mul_f32 v[182:183], v[182:183], v[54:55]
    v_pk_mul_f32 v[184:185], v[184:185], v[56:57]
    v_pk_mul_f32 v[186:187], v[186:187], v[58:59]
    v_pk_mul_f32 v[188:189], v[188:189], v[60:61]
    v_pk_mul_f32 v[190:191], v[190:191], v[62:63]
    v_exp_f32 v176, v176
    v_exp_f32 v177, v177
    v_exp_f32 v178, v178
    v_exp_f32 v179, v179
    v_exp_f32 v180, v180
    v_exp_f32 v181, v181
    v_exp_f32 v182, v182
    v_exp_f32 v183, v183
    v_exp_f32 v184, v184
    v_exp_f32 v185, v185
    v_exp_f32 v186, v186
    v_exp_f32 v187, v187
    v_exp_f32 v188, v188
    v_exp_f32 v189, v189
    v_exp_f32 v190, v190
    v_exp_f32 v191, v191
    v_pk_fma_f32 v[176:177], v[176:177], v[194:195], v[194:195]
    v_pk_fma_f32 v[178:179], v[178:179], v[194:195], v[194:195]
    v_pk_fma_f32 v[180:181], v[180:181], v[194:195], v[194:195]
    v_pk_fma_f32 v[182:183], v[182:183], v[194:195], v[194:195]
    v_pk_fma_f32 v[184:185], v[184:185], v[194:195], v[194:195]
    v_pk_fma_f32 v[186:187], v[186:187], v[194:195], v[194:195]
    v_pk_fma_f32 v[188:189], v[188:189], v[194:195], v[194:195]
    v_pk_fma_f32 v[190:191], v[190:191], v[194:195], v[194:195]
    v_rcp_f32 v176, v176
    v_rcp_f32 v177, v177
    v_rcp_f32 v178, v178
    v_rcp_f32 v179, v179
    v_rcp_f32 v180, v180
    v_rcp_f32 v181, v181
    v_rcp_f32 v182, v182
    v_rcp_f32 v183, v183
    v_rcp_f32 v184, v184
    v_rcp_f32 v185, v185
    v_rcp_f32 v186, v186
    v_rcp_f32 v187, v187
    v_rcp_f32 v188, v188
    v_rcp_f32 v189, v189
    v_rcp_f32 v190, v190
    v_rcp_f32 v191, v191
    v_pk_mul_f32 v[48:49], v[48:49], v[80:81]
    v_pk_mul_f32 v[50:51], v[50:51], v[82:83]
    v_pk_mul_f32 v[52:53], v[52:53], v[84:85]
    v_pk_mul_f32 v[54:55], v[54:55], v[86:87]
    v_pk_mul_f32 v[56:57], v[56:57], v[88:89]
    v_pk_mul_f32 v[58:59], v[58:59], v[90:91]
    v_pk_mul_f32 v[60:61], v[60:61], v[92:93]
    v_pk_mul_f32 v[62:63], v[62:63], v[94:95]
    v_pk_mul_f32 v[48:49], v[48:49], v[176:177]
    v_pk_mul_f32 v[50:51], v[50:51], v[178:179]
    v_pk_mul_f32 v[52:53], v[52:53], v[180:181]
    v_pk_mul_f32 v[54:55], v[54:55], v[182:183]
    v_pk_mul_f32 v[56:57], v[56:57], v[184:185]
    v_pk_mul_f32 v[58:59], v[58:59], v[186:187]
    v_pk_mul_f32 v[60:61], v[60:61], v[188:189]
    v_pk_mul_f32 v[62:63], v[62:63], v[190:191]
    v_cvt_pk_bf16_f32 v48, v48, v49
    v_cvt_pk_bf16_f32 v49, v50, v51
    v_cvt_pk_bf16_f32 v50, v52, v53
    v_cvt_pk_bf16_f32 v51, v54, v55
    v_cvt_pk_bf16_f32 v52, v56, v57
    v_cvt_pk_bf16_f32 v53, v58, v59
    v_cvt_pk_bf16_f32 v54, v60, v61
    v_cvt_pk_bf16_f32 v55, v62, v63
    buffer_store_dwordx4 v[48:51], v232, s[20:23], s58 offen sc1
    buffer_store_dwordx4 v[52:55], v232, s[20:23], s58 offen offset:1024 sc1
L_g1B:
    buffer_load_dwordx4 v[100:103], v254, s[40:43], 0 offen
    s_setprio 0
    s_barrier
    s_waitcnt vmcnt(1)
    buffer_load_dword v235, v247, s[20:23], s65 offen sc1
    s_mov_b64 exec, 1
    buffer_store_dword v232, off, s[20:23], s64 sc1
    s_mov_b64 exec, -1
    s_waitcnt vmcnt(1)
L_join:
    s_add_u32 s64, s64, 4096
    s_add_u32 s80, s80, 4096
    v_cmp_eq_u32 vcc, -1, v235
    s_cbranch_vccnz L_es
L_ek:
    buffer_load_dwordx4 v[32:35], v232, s[20:23], s8 offen offset:0 sc1
    buffer_load_dwordx4 v[36:39], v232, s[20:23], s8 offen offset:1024 sc1
    s_cmp_gt_u32 s50, 2
    s_cbranch_scc1 L_nokl
    s_add_u32 s3, s61, 0
    buffer_load_dwordx4 v[176:179], v237, s[20:23], s3 offen sc1
    s_add_u32 s3, s61, 4096
    buffer_load_dwordx4 v[180:183], v237, s[20:23], s3 offen sc1
    s_add_u32 s3, s61, 8192
    buffer_load_dwordx4 v[184:187], v237, s[20:23], s3 offen sc1
    s_add_u32 s3, s61, 12288
    buffer_load_dwordx4 v[188:191], v237, s[20:23], s3 offen sc1
    s_add_u32 s3, s61, 16384
    buffer_load_dwordx4 v[192:195], v237, s[20:23], s3 offen sc1
    s_add_u32 s3, s61, 20480
    buffer_load_dwordx4 v[196:199], v237, s[20:23], s3 offen sc1
    s_add_u32 s3, s61, 24576
    buffer_load_dwordx4 v[200:203], v237, s[20:23], s3 offen sc1
    s_add_u32 s3, s61, 28672
    buffer_load_dwordx4 v[204:207], v237, s[20:23], s3 offen sc1
L_nokl:
    buffer_load_dwordx4 v[40:43], v232, s[20:23], s9 offen offset:0 sc1
    buffer_load_dwordx4 v[44:47], v232, s[20:23], s9 offen offset:1024 sc1
    buffer_load_dwordx4 v[48:51], v232, s[20:23], s10 offen offset:0 sc1
    v_max3_u32 v15, v228, v229, v230
    v_max_u32 v15, v15, v231
    v_cmp_eq_u32 vcc, -1, v15
    s_cbranch_vccnz L_qs
L_qk:
    v_mfma_f32_32x32x16_bf16 v[16:31], v[220:223], v[228:231], 0
    buffer_load_dwordx4 v[52:55], v232, s[20:23], s10 offen offset:1024 sc1
    s_nop 10
    v_max3_f32 v208, v16, v17, v18
    v_max3_f32 v209, v19, v20, v21
    v_max3_f32 v210, v22, v23, v24
    v_max3_f32 v211, v25, v26, v27
    v_max3_f32 v208, v208, v28, v29
    v_max3_f32 v209, v209, v30, v31
    v_max3_f32 v208, v208, v210, v211
    v_max_f32 v208, v208, v209
    buffer_load_dwordx4 v[56:59], v232, s[20:23], s11 offen offset:0 sc1
    v_mul_f32 v209, 0xbfb8aa3b, v208
    v_mul_f32 v208, 0xbfb8aa3b, v208
    v_pk_fma_f32 v[16:17], v[16:17], s[72:73], v[208:209]
    v_pk_fma_f32 v[18:19], v[18:19], s[72:73], v[208:209]
    v_pk_fma_f32 v[20:21], v[20:21], s[72:73], v[208:209]
    v_pk_fma_f32 v[22:23], v[22:23], s[72:73], v[208:209]
    v_pk_fma_f32 v[24:25], v[24:25], s[72:73], v[208:209]
    v_pk_fma_f32 v[26:27], v[26:27], s[72:73], v[208:209]
    v_pk_fma_f32 v[28:29], v[28:29], s[72:73], v[208:209]
    buffer_load_dwordx4 v[60:63], v232, s[20:23], s11 offen offset:1024 sc1
    v_pk_fma_f32 v[30:31], v[30:31], s[72:73], v[208:209]
    v_exp_f32 v16, v16
    v_exp_f32 v17, v17
    v_exp_f32 v18, v18
    v_exp_f32 v19, v19
    v_exp_f32 v20, v20
    v_exp_f32 v21, v21
    v_exp_f32 v22, v22
    v_exp_f32 v23, v23
    buffer_load_dwordx4 v[64:67], v232, s[20:23], s12 offen offset:0 sc1
    v_exp_f32 v24, v24
    v_exp_f32 v25, v25
    v_exp_f32 v26, v26
    v_exp_f32 v27, v27
    v_exp_f32 v28, v28
    v_exp_f32 v29, v29
    v_exp_f32 v30, v30
    v_exp_f32 v31, v31
    buffer_load_dword v235, v247, s[20:23], s65 offen offset:2048 sc1
    v_pk_add_f32 v[210:211], v[16:17], v[18:19]
    v_pk_add_f32 v[212:213], v[20:21], v[22:23]
    v_pk_add_f32 v[214:215], v[24:25], v[26:27]
    v_pk_add_f32 v[216:217], v[28:29], v[30:31]
    v_pk_add_f32 v[210:211], v[210:211], v[212:213]
    v_pk_add_f32 v[214:215], v[214:215], v[216:217]
    v_pk_add_f32 v[210:211], v[210:211], v[214:215]
    v_add_f32 v208, v210, v211
    v_rcp_f32 v208, v208
    buffer_load_dwordx4 v[68:71], v232, s[20:23], s12 offen offset:1024 sc1
    v_mov_b32 v209, v208
    v_pk_mul_f32 v[16:17], v[16:17], v[208:209]
    v_pk_mul_f32 v[18:19], v[18:19], v[208:209]
    v_pk_mul_f32 v[20:21], v[20:21], v[208:209]
    v_pk_mul_f32 v[22:23], v[22:23], v[208:209]
    v_pk_mul_f32 v[24:25], v[24:25], v[208:209]
    v_pk_mul_f32 v[26:27], v[26:27], v[208:209]
    v_pk_mul_f32 v[28:29], v[28:29], v[208:209]
    v_pk_mul_f32 v[30:31], v[30:31], v[208:209]
    buffer_load_dwordx4 v[72:75], v232, s[20:23], s13 offen offset:0 sc1
    v_cvt_pk_bf16_f32 v104, v16, v17
    v_cvt_pk_bf16_f32 v105, v18, v19
    v_cvt_pk_bf16_f32 v106, v20, v21
    v_cvt_pk_bf16_f32 v107, v22, v23
    v_cvt_pk_bf16_f32 v108, v24, v25
    v_cvt_pk_bf16_f32 v109, v26, v27
    v_cvt_pk_bf16_f32 v110, v28, v29
    v_cvt_pk_bf16_f32 v111, v30, v31
    s_cmp_gt_u32 s50, 2
    s_cbranch_scc1 L_nosum
    s_waitcnt vmcnt(10)
    v_max3_u32 v10, v176, v177, v178
    v_max3_u32 v11, v179, v180, v181
    v_max3_u32 v10, v10, v182, v183
    v_max3_u32 v11, v11, v184, v185
    v_max3_u32 v10, v10, v186, v187
    v_max3_u32 v11, v11, v188, v189
    v_max3_u32 v10, v10, v190, v191
    v_max3_u32 v11, v11, v192, v193
    v_max3_u32 v10, v10, v194, v195
    v_max3_u32 v11, v11, v196, v197
    v_max3_u32 v10, v10, v198, v199
    v_max3_u32 v11, v11, v200, v201
    v_max3_u32 v10, v10, v202, v203
    v_max3_u32 v11, v11, v204, v205
    v_max3_u32 v10, v10, v206, v207
    v_max_u32 v10, v10, v11
    v_cmp_eq_u32 vcc, -1, v10
    s_cbranch_vccnz L_kvs
L_kvk:
    v_add_f32 v176, v176, v192
    v_add_f32 v177, v177, v193
    v_add_f32 v178, v178, v194
    v_add_f32 v179, v179, v195
    v_add_f32 v180, v180, v196
    v_add_f32 v181, v181, v197
    v_add_f32 v182, v182, v198
    v_add_f32 v183, v183, v199
    v_add_f32 v184, v184, v200
    v_add_f32 v185, v185, v201
    v_add_f32 v186, v186, v202
    v_add_f32 v187, v187, v203
    v_add_f32 v188, v188, v204
    v_add_f32 v189, v189, v205
    v_add_f32 v190, v190, v206
    v_add_f32 v191, v191, v207
    v_add_f32 v176, v176, v184
    v_add_f32 v177, v177, v185
    v_add_f32 v178, v178, v186
    v_add_f32 v179, v179, v187
    v_add_f32 v180, v180, v188
    v_add_f32 v181, v181, v189
    v_add_f32 v182, v182, v190
    v_add_f32 v183, v183, v191
    v_add_f32 v176, v176, v180
    v_add_f32 v177, v177, v181
    v_add_f32 v178, v178, v182
    v_add_f32 v179, v179, v183
    v_cvt_pk_bf16_f32 v10, v176, v177
    v_cvt_pk_bf16_f32 v11, v178, v179
    v_lshlrev_b32 v15, 3, v0
    v_add_u32 v15, 161792, v15
    ds_write_b64 v15, v[10:11]
L_nosum:
    s_waitcnt vmcnt(11)
    v_mfma_f32_32x32x16_bf16 v[176:191], v[112:115], v[32:35], 0
    buffer_load_dwordx4 v[76:79], v232, s[20:23], s13 offen offset:1024 sc1
    v_mfma_f32_32x32x16_bf16 v[192:207], v[116:119], v[32:35], 0
    s_waitcnt vmcnt(11) lgkmcnt(0)
    s_barrier
    v_mfma_f32_32x32x16_bf16 v[176:191], v[120:123], v[36:39], v[176:191]
    ds_read2_b64 v[208:211], v243 offset0:0 offset1:34
    ds_read2_b64 v[212:215], v243 offset0:68 offset1:102
    buffer_load_dwordx4 v[80:83], v232, s[20:23], s14 offen offset:0 sc1
    v_mfma_f32_32x32x16_bf16 v[192:207], v[124:127], v[36:39], v[192:207]
    s_waitcnt vmcnt(11) lgkmcnt(0)
    v_mfma_f32_32x32x16_bf16 v[176:191], v[128:131], v[40:43], v[176:191]
    v_mfma_f32_32x32x16_bf16 v[16:31], v[208:211], v[104:107], 0
    v_mfma_f32_32x32x16_bf16 v[16:31], v[212:215], v[108:111], v[16:31]
    buffer_load_dwordx4 v[84:87], v232, s[20:23], s14 offen offset:1024 sc1
    v_mfma_f32_32x32x16_bf16 v[192:207], v[132:135], v[40:43], v[192:207]
    s_nop 9
    v_add_f32 v24, 0x358637bd, v24
    v_rcp_f32 v24, v24
    s_nop 0
    v_mul_f32 v16, v16, v24
    v_mul_f32 v17, v17, v24
    v_mul_f32 v18, v18, v24
    v_mul_f32 v19, v19, v24
    v_mul_f32 v20, v20, v24
    v_mul_f32 v21, v21, v24
    v_mul_f32 v22, v22, v24
    v_mul_f32 v23, v23, v24
    v_cvt_pk_bf16_f32 v96, v16, v17
    v_cvt_pk_bf16_f32 v97, v18, v19
    v_cvt_pk_bf16_f32 v98, v20, v21
    v_cvt_pk_bf16_f32 v99, v22, v23
    buffer_store_dwordx4 v[96:99], v232, s[20:23], s62 offen sc1
    s_waitcnt vmcnt(6)
    v_cmp_eq_u32 vcc, -1, v235
    s_cbranch_vccnz L_ls
L_lk:
    v_mfma_f32_32x32x16_bf16 v[176:191], v[136:139], v[44:47], v[176:191]
    buffer_load_dwordx4 v[88:91], v218, s[20:23], s8 offen offset:0 sc1
    v_mfma_f32_32x32x16_bf16 v[192:207], v[140:143], v[44:47], v[192:207]
    s_waitcnt vmcnt(12)
    v_mfma_f32_32x32x16_bf16 v[176:191], v[144:147], v[48:51], v[176:191]
    buffer_load_dwordx4 v[92:95], v218, s[20:23], s8 offen offset:1024 sc1
    v_mfma_f32_32x32x16_bf16 v[192:207], v[148:151], v[48:51], v[192:207]
    s_waitcnt vmcnt(12)
    v_mfma_f32_32x32x16_bf16 v[176:191], v[152:155], v[52:55], v[176:191]
    ds_read_b64_tr_b16 v[128:129], v248 offset:32768
    ds_read_b64_tr_b16 v[130:131], v248 offset:33792
    ds_read_b64_tr_b16 v[132:133], v249 offset:32768
    ds_read_b64_tr_b16 v[134:135], v249 offset:33792
    buffer_load_dwordx4 v[32:35], v218, s[20:23], s9 offen offset:0 sc1
    v_mfma_f32_32x32x16_bf16 v[192:207], v[156:159], v[52:55], v[192:207]
    s_waitcnt vmcnt(12)
    v_mfma_f32_32x32x16_bf16 v[176:191], v[160:163], v[56:59], v[176:191]
    ds_read_b64_tr_b16 v[136:137], v248 offset:34816
    ds_read_b64_tr_b16 v[138:139], v248 offset:35840
    ds_read_b64_tr_b16 v[140:141], v249 offset:34816
    ds_read_b64_tr_b16 v[142:143], v249 offset:35840
    buffer_load_dwordx4 v[36:39], v218, s[20:23], s9 offen offset:1024 sc1
    v_mfma_f32_32x32x16_bf16 v[192:207], v[164:167], v[56:59], v[192:207]
    s_waitcnt vmcnt(12)
    v_mfma_f32_32x32x16_bf16 v[176:191], v[168:171], v[60:63], v[176:191]
    ds_read_b64_tr_b16 v[16:17], v248 offset:36864
    ds_read_b64_tr_b16 v[18:19], v248 offset:37888
    ds_read_b64_tr_b16 v[20:21], v249 offset:36864
    ds_read_b64_tr_b16 v[22:23], v249 offset:37888
    buffer_load_dwordx4 v[40:43], v218, s[20:23], s10 offen offset:0 sc1
    v_mfma_f32_32x32x16_bf16 v[192:207], v[172:175], v[60:63], v[192:207]
    s_waitcnt vmcnt(12) lgkmcnt(8)
    v_mfma_f32_32x32x16_bf16 v[176:191], v[128:131], v[64:67], v[176:191]
    ds_read_b64_tr_b16 v[24:25], v248 offset:38912
    ds_read_b64_tr_b16 v[26:27], v248 offset:39936
    ds_read_b64_tr_b16 v[28:29], v249 offset:38912
    ds_read_b64_tr_b16 v[30:31], v249 offset:39936
    buffer_load_dwordx4 v[44:47], v218, s[20:23], s10 offen offset:1024 sc1
    v_mfma_f32_32x32x16_bf16 v[192:207], v[132:135], v[64:67], v[192:207]
    s_waitcnt vmcnt(11) lgkmcnt(8)
    v_mfma_f32_32x32x16_bf16 v[176:191], v[136:139], v[68:71], v[176:191]
    ds_read_b64_tr_b16 v[128:129], v250 offset:32768
    ds_read_b64_tr_b16 v[130:131], v250 offset:33792
    ds_read_b64_tr_b16 v[132:133], v251 offset:32768
    ds_read_b64_tr_b16 v[134:135], v251 offset:33792
    buffer_load_dwordx4 v[48:51], v218, s[20:23], s11 offen offset:0 sc1
    v_mfma_f32_32x32x16_bf16 v[192:207], v[140:143], v[68:71], v[192:207]
    s_waitcnt vmcnt(7) lgkmcnt(4)
    s_barrier
    s_mov_b64 exec, 1
    buffer_store_dword v232, off, s[20:23], s64 sc1
    s_mov_b64 exec, -1
    v_mfma_f32_32x32x16_bf16 v[176:191], v[16:19], v[72:75], v[176:191]
    ds_read_b64_tr_b16 v[136:137], v250 offset:34816
    ds_read_b64_tr_b16 v[138:139], v250 offset:35840
    ds_read_b64_tr_b16 v[140:141], v251 offset:34816
    ds_read_b64_tr_b16 v[142:143], v251 offset:35840
    s_cmp_lg_u32 s50, 3
    s_cbranch_scc1 L_no6b
    s_add_u32 m0, s55, 147456
    s_add_u32 s0, s68, 5
    s_sub_u32 s1, s0, 7
    s_min_u32 s0, s0, s1
    s_lshl_b32 s0, s0, 16
    s_add_u32 s0, s0, s79
    s_add_u32 s0, s0, 950272
    buffer_load_dwordx4 v4, s[32:35], s0 offen offset:2048 lds
    buffer_load_dwordx4 v7, s[32:35], s0 offen offset:3072 lds
L_no6b:
    s_add_u32 m0, s55, 32768
    s_lshl_b32 s0, s78, 15
    s_add_u32 s0, s0, s67
    s_and_b32 s0, s0, 0x18000
    buffer_load_dwordx4 v14, s[36:39], s0 offen offset:0 lds
    v_mfma_f32_32x32x16_bf16 v[192:207], v[20:23], v[72:75], v[192:207]
    s_waitcnt vmcnt(12) lgkmcnt(8)
    v_mfma_f32_32x32x16_bf16 v[176:191], v[24:27], v[76:79], v[176:191]
    ds_read_b64_tr_b16 v[16:17], v250 offset:36864
    ds_read_b64_tr_b16 v[18:19], v250 offset:37888
    ds_read_b64_tr_b16 v[20:21], v251 offset:36864
    ds_read_b64_tr_b16 v[22:23], v251 offset:37888
    buffer_load_dwordx4 v2, s[36:39], s0 offen offset:1024 lds
    v_mfma_f32_32x32x16_bf16 v[192:207], v[28:31], v[76:79], v[192:207]
    s_waitcnt vmcnt(12) lgkmcnt(8)
    v_mfma_f32_32x32x16_bf16 v[176:191], v[128:131], v[80:83], v[176:191]
    ds_read_b64_tr_b16 v[24:25], v250 offset:38912
    ds_read_b64_tr_b16 v[26:27], v250 offset:39936
    ds_read_b64_tr_b16 v[28:29], v251 offset:38912
    ds_read_b64_tr_b16 v[30:31], v251 offset:39936
    buffer_load_dwordx4 v4, s[36:39], s0 offen offset:2048 lds
    v_mfma_f32_32x32x16_bf16 v[192:207], v[132:135], v[80:83], v[192:207]
    s_waitcnt vmcnt(12) lgkmcnt(8)
    v_mfma_f32_32x32x16_bf16 v[176:191], v[136:139], v[84:87], v[176:191]
    ds_read_b64_tr_b16 v[128:129], v250 offset:0
    ds_read_b64_tr_b16 v[130:131], v250 offset:1024
    ds_read_b64_tr_b16 v[132:133], v251 offset:0
    ds_read_b64_tr_b16 v[134:135], v251 offset:1024
    buffer_load_dwordx4 v7, s[36:39], s0 offen offset:3072 lds
    v_mfma_f32_32x32x16_bf16 v[192:207], v[140:143], v[84:87], v[192:207]
    s_waitcnt vmcnt(11) lgkmcnt(4)
    s_barrier
    v_mfma_f32_32x32x16_bf16 v[176:191], v[16:19], v[88:91], v[176:191]
    ds_read_b64_tr_b16 v[136:137], v250 offset:2048
    ds_read_b64_tr_b16 v[138:139], v250 offset:3072
    ds_read_b64_tr_b16 v[140:141], v251 offset:2048
    ds_read_b64_tr_b16 v[142:143], v251 offset:3072
    s_add_u32 m0, s55, 98304
    s_lshl_b32 s0, s78, 15
    s_add_u32 s0, s0, s67
    s_add_u32 s0, s0, 65536
    s_and_b32 s0, s0, 0x18000
    buffer_load_dwordx4 v14, s[36:39], s0 offen offset:0 lds
    v_mfma_f32_32x32x16_bf16 v[192:207], v[20:23], v[88:91], v[192:207]
    s_waitcnt vmcnt(11) lgkmcnt(8)
    v_mfma_f32_32x32x16_bf16 v[176:191], v[24:27], v[92:95], v[176:191]
    ds_read_b64_tr_b16 v[16:17], v250 offset:4096
    ds_read_b64_tr_b16 v[18:19], v250 offset:5120
    ds_read_b64_tr_b16 v[20:21], v251 offset:4096
    ds_read_b64_tr_b16 v[22:23], v251 offset:5120
    buffer_load_dwordx4 v2, s[36:39], s0 offen offset:1024 lds
    v_mfma_f32_32x32x16_bf16 v[192:207], v[28:31], v[92:95], v[192:207]
    s_waitcnt vmcnt(11) lgkmcnt(8)
    v_mfma_f32_32x32x16_bf16 v[176:191], v[128:131], v[32:35], v[176:191]
    ds_read_b64_tr_b16 v[24:25], v250 offset:6144
    ds_read_b64_tr_b16 v[26:27], v250 offset:7168
    ds_read_b64_tr_b16 v[28:29], v251 offset:6144
    ds_read_b64_tr_b16 v[30:31], v251 offset:7168
    buffer_load_dwordx4 v[52:55], v218, s[20:23], s11 offen offset:1024 sc1
    v_mfma_f32_32x32x16_bf16 v[192:207], v[132:135], v[32:35], v[192:207]
    s_waitcnt vmcnt(11) lgkmcnt(8)
    v_mfma_f32_32x32x16_bf16 v[176:191], v[136:139], v[36:39], v[176:191]
    ds_read_b64_tr_b16 v[128:129], v248 offset:0
    ds_read_b64_tr_b16 v[130:131], v248 offset:1024
    ds_read_b64_tr_b16 v[132:133], v249 offset:0
    ds_read_b64_tr_b16 v[134:135], v249 offset:1024
    buffer_load_dwordx4 v[56:59], v218, s[20:23], s12 offen offset:0 sc1
    buffer_load_dwordx4 v4, s[36:39], s0 offen offset:2048 lds
    v_mfma_f32_32x32x16_bf16 v[192:207], v[140:143], v[36:39], v[192:207]
    s_waitcnt vmcnt(12) lgkmcnt(8)
    v_mfma_f32_32x32x16_bf16 v[176:191], v[16:19], v[40:43], v[176:191]
    ds_read_b64_tr_b16 v[136:137], v248 offset:2048
    ds_read_b64_tr_b16 v[138:139], v248 offset:3072
    ds_read_b64_tr_b16 v[140:141], v249 offset:2048
    ds_read_b64_tr_b16 v[142:143], v249 offset:3072
    buffer_load_dword v235, v247, s[20:23], s80 offen sc1
    buffer_load_dwordx4 v[60:63], v218, s[20:23], s12 offen offset:1024 sc1
    buffer_load_dwordx4 v7, s[36:39], s0 offen offset:3072 lds
    v_mfma_f32_32x32x16_bf16 v[192:207], v[20:23], v[40:43], v[192:207]
    s_waitcnt vmcnt(14) lgkmcnt(8)
    v_mfma_f32_32x32x16_bf16 v[176:191], v[24:27], v[44:47], v[176:191]
    ds_read_b64_tr_b16 v[16:17], v248 offset:4096
    ds_read_b64_tr_b16 v[18:19], v248 offset:5120
    ds_read_b64_tr_b16 v[20:21], v249 offset:4096
    ds_read_b64_tr_b16 v[22:23], v249 offset:5120
    buffer_load_dwordx4 v[64:67], v218, s[20:23], s13 offen offset:0 sc1
    v_mfma_f32_32x32x16_bf16 v[192:207], v[28:31], v[44:47], v[192:207]
    s_waitcnt vmcnt(14) lgkmcnt(8)
    v_mfma_f32_32x32x16_bf16 v[176:191], v[128:131], v[48:51], v[176:191]
    ds_read_b64_tr_b16 v[24:25], v248 offset:6144
    ds_read_b64_tr_b16 v[26:27], v248 offset:7168
    ds_read_b64_tr_b16 v[28:29], v249 offset:6144
    ds_read_b64_tr_b16 v[30:31], v249 offset:7168
    buffer_load_dwordx4 v[68:71], v218, s[20:23], s13 offen offset:1024 sc1
    v_mfma_f32_32x32x16_bf16 v[192:207], v[132:135], v[48:51], v[192:207]
    s_waitcnt vmcnt(2) lgkmcnt(0)
    s_barrier
    v_mfma_f32_32x32x16_bf16 v[176:191], v[136:139], v[52:55], v[176:191]
    ds_read_b64_tr_b16 v[128:129], v252 offset:0
    ds_read_b64_tr_b16 v[130:131], v252 offset:1024
    ds_read_b64_tr_b16 v[132:133], v253 offset:0
    ds_read_b64_tr_b16 v[134:135], v253 offset:1024
    buffer_load_dwordx4 v[72:75], v218, s[20:23], s14 offen offset:0 sc1
    v_mfma_f32_32x32x16_bf16 v[192:207], v[140:143], v[52:55], v[192:207]
    s_waitcnt vmcnt(5) lgkmcnt(8)
    v_cmp_eq_u32 vcc, -1, v235
    s_cbranch_vccnz L_os
L_ok:
    v_mfma_f32_32x32x16_bf16 v[176:191], v[16:19], v[56:59], v[176:191]
    ds_read_b64_tr_b16 v[136:137], v252 offset:2048
    ds_read_b64_tr_b16 v[138:139], v252 offset:3072
    ds_read_b64_tr_b16 v[140:141], v253 offset:2048
    ds_read_b64_tr_b16 v[142:143], v253 offset:3072
    buffer_load_dwordx4 v[76:79], v218, s[20:23], s14 offen offset:1024 sc1
    v_mfma_f32_32x32x16_bf16 v[192:207], v[20:23], v[56:59], v[192:207]
    s_waitcnt vmcnt(5) lgkmcnt(8)
    v_mfma_f32_32x32x16_bf16 v[176:191], v[24:27], v[60:63], v[176:191]
    ds_read_b64_tr_b16 v[16:17], v252 offset:4096
    ds_read_b64_tr_b16 v[18:19], v252 offset:5120
    ds_read_b64_tr_b16 v[20:21], v253 offset:4096
    ds_read_b64_tr_b16 v[22:23], v253 offset:5120
    buffer_load_dwordx4 v[80:83], v218, s[20:23], s15 offen offset:0 sc1
    v_mfma_f32_32x32x16_bf16 v[192:207], v[28:31], v[60:63], v[192:207]
    s_waitcnt vmcnt(4) lgkmcnt(8)
    v_mfma_f32_32x32x16_bf16 v[176:191], v[128:131], v[64:67], v[176:191]
    ds_read_b64_tr_b16 v[24:25], v252 offset:6144
    ds_read_b64_tr_b16 v[26:27], v252 offset:7168
    ds_read_b64_tr_b16 v[28:29], v253 offset:6144
    ds_read_b64_tr_b16 v[30:31], v253 offset:7168
    buffer_load_dwordx4 v[84:87], v218, s[20:23], s15 offen offset:1024 sc1
    s_and_b32 s3, s50, 1
    s_lshl_b32 s3, s3, 13
    s_and_b32 s28, s70, 1
    s_lshl_b32 s28, s28, 14
    s_add_u32 s3, s3, s28
    s_lshr_b32 s28, s70, 1
    s_lshl_b32 s29, s28, 16
    s_add_u32 s3, s3, s29
    s_lshl_b32 s28, s28, 15
    s_add_u32 s28, s28, 32768
    v_and_b32 v5, 15, v8
    v_xor_b32 v5, v5, v9
    v_lshlrev_b32 v5, 4, v5
    v_lshl_add_u32 v5, v8, 8, v5
    v_add_u32 v224, s3, v5
    v_xor_b32 v225, 32, v224
    v_xor_b32 v226, 64, v224
    v_xor_b32 v227, 96, v224
    v_xor_b32 v228, 128, v224
    v_xor_b32 v229, 160, v224
    v_xor_b32 v230, 192, v224
    v_xor_b32 v231, 224, v224
    v_mfma_f32_32x32x16_bf16 v[192:207], v[132:135], v[64:67], v[192:207]
    s_waitcnt vmcnt(4) lgkmcnt(8)
    v_mfma_f32_32x32x16_bf16 v[176:191], v[136:139], v[68:71], v[176:191]
    ds_read_b64_tr_b16 v[144:145], v248 offset:32768
    ds_read_b64_tr_b16 v[146:147], v248 offset:33792
    ds_read_b64_tr_b16 v[148:149], v249 offset:32768
    ds_read_b64_tr_b16 v[150:151], v249 offset:33792
    ds_read_b64_tr_b16 v[152:153], v248 offset:34816
    ds_read_b64_tr_b16 v[154:155], v248 offset:35840
    ds_read_b64_tr_b16 v[156:157], v249 offset:34816
    ds_read_b64_tr_b16 v[158:159], v249 offset:35840
    buffer_load_dwordx4 v[88:91], v218, s[20:23], s16 offen offset:0 sc1
    v_and_b32 v5, 15, v13
    v_lshlrev_b32 v6, 1, v3
    v_xor_b32 v5, v5, v6
    v_lshlrev_b32 v5, 4, v5
    v_lshl_add_u32 v233, v13, 8, v5
    v_xor_b32 v234, 16, v233
    v_add_u32 v235, 0x10000, v233
    v_add_u32 v236, 0x10000, v234
    v_add_u32 v237, 0x20000, v233
    v_add_u32 v238, 0x20000, v234
    v_mfma_f32_32x32x16_bf16 v[192:207], v[140:143], v[68:71], v[192:207]
    s_waitcnt vmcnt(4) lgkmcnt(12)
    v_mfma_f32_32x32x16_bf16 v[176:191], v[16:19], v[72:75], v[176:191]
    ds_read_b64_tr_b16 v[160:161], v248 offset:36864
    ds_read_b64_tr_b16 v[162:163], v248 offset:37888
    ds_read_b64_tr_b16 v[164:165], v249 offset:36864
    ds_read_b64_tr_b16 v[166:167], v249 offset:37888
    ds_read_b64_tr_b16 v[168:169], v248 offset:38912
    ds_read_b64_tr_b16 v[170:171], v248 offset:39936
    ds_read_b64_tr_b16 v[172:173], v249 offset:38912
    ds_read_b64_tr_b16 v[174:175], v249 offset:39936
    buffer_load_dwordx4 v[92:95], v218, s[20:23], s16 offen offset:1024 sc1
    v_mfma_f32_32x32x16_bf16 v[192:207], v[20:23], v[72:75], v[192:207]
    s_waitcnt vmcnt(4) lgkmcnt(8)
    v_mfma_f32_32x32x16_bf16 v[176:191], v[24:27], v[76:79], v[176:191]
    buffer_load_dwordx4 v[32:35], v218, s[20:23], s17 offen offset:0 sc1
    v_mfma_f32_32x32x16_bf16 v[192:207], v[28:31], v[76:79], v[192:207]
    s_waitcnt lgkmcnt(0)
    ds_read_b64_tr_b16 v[48:49], v250 offset:32768
    ds_read_b64_tr_b16 v[50:51], v250 offset:33792
    ds_read_b64_tr_b16 v[52:53], v251 offset:32768
    ds_read_b64_tr_b16 v[54:55], v251 offset:33792
    ds_read_b64_tr_b16 v[56:57], v250 offset:34816
    ds_read_b64_tr_b16 v[58:59], v250 offset:35840
    ds_read_b64_tr_b16 v[60:61], v251 offset:34816
    ds_read_b64_tr_b16 v[62:63], v251 offset:35840
    ds_read_b64_tr_b16 v[64:65], v250 offset:36864
    ds_read_b64_tr_b16 v[66:67], v250 offset:37888
    ds_read_b64_tr_b16 v[68:69], v251 offset:36864
    ds_read_b64_tr_b16 v[70:71], v251 offset:37888
    ds_read_b64_tr_b16 v[72:73], v250 offset:38912
    ds_read_b64_tr_b16 v[74:75], v250 offset:39936
    ds_read_b64_tr_b16 v[76:77], v251 offset:38912
    ds_read_b64_tr_b16 v[78:79], v251 offset:39936
    s_waitcnt vmcnt(4)
    v_mfma_f32_32x32x16_bf16 v[112:127], v[144:147], v[80:83], 0
    buffer_load_dwordx4 v[36:39], v218, s[20:23], s17 offen offset:1024 sc1
    ds_write_b128 v224, v[176:179]
    v_mfma_f32_32x32x16_bf16 v[128:143], v[148:151], v[80:83], 0
    v_add_u32 v224, s28, v224
    s_waitcnt vmcnt(4)
    v_mfma_f32_32x32x16_bf16 v[112:127], v[152:155], v[84:87], v[112:127]
    buffer_load_dwordx4 v[40:43], v218, s[20:23], s18 offen offset:0 sc1
    ds_write_b128 v225, v[180:183]
    v_mfma_f32_32x32x16_bf16 v[128:143], v[156:159], v[84:87], v[128:143]
    v_add_u32 v225, s28, v225
    s_waitcnt vmcnt(4)
    v_mfma_f32_32x32x16_bf16 v[112:127], v[160:163], v[88:91], v[112:127]
    buffer_load_dwordx4 v[44:47], v218, s[20:23], s18 offen offset:1024 sc1
    ds_write_b128 v226, v[184:187]
    v_lshlrev_b32 v208, 16, v100
    v_and_b32 v209, 0xffff0000, v100
    v_lshlrev_b32 v210, 16, v101
    v_and_b32 v211, 0xffff0000, v101
    v_lshlrev_b32 v212, 16, v102
    v_and_b32 v213, 0xffff0000, v102
    v_lshlrev_b32 v214, 16, v103
    v_and_b32 v215, 0xffff0000, v103
    v_mfma_f32_32x32x16_bf16 v[128:143], v[164:167], v[88:91], v[128:143]
    v_add_u32 v226, s28, v226
    s_waitcnt vmcnt(4)
    v_mfma_f32_32x32x16_bf16 v[112:127], v[168:171], v[92:95], v[112:127]
    ds_write_b128 v227, v[188:191]
    v_mfma_f32_32x32x16_bf16 v[128:143], v[172:175], v[92:95], v[128:143]
    v_add_u32 v227, s28, v227
    s_waitcnt vmcnt(3) lgkmcnt(4)
    v_mfma_f32_32x32x16_bf16 v[112:127], v[48:51], v[32:35], v[112:127]
    ds_write_b128 v228, v[192:195]
    v_mfma_f32_32x32x16_bf16 v[128:143], v[52:55], v[32:35], v[128:143]
    v_add_u32 v228, s28, v228
    s_waitcnt vmcnt(2)
    v_mfma_f32_32x32x16_bf16 v[112:127], v[56:59], v[36:39], v[112:127]
    ds_write_b128 v229, v[196:199]
    v_mfma_f32_32x32x16_bf16 v[128:143], v[60:63], v[36:39], v[128:143]
    v_add_u32 v229, s28, v229
    s_waitcnt vmcnt(1)
    v_mfma_f32_32x32x16_bf16 v[112:127], v[64:67], v[40:43], v[112:127]
    ds_write_b128 v230, v[200:203]
    v_mfma_f32_32x32x16_bf16 v[128:143], v[68:71], v[40:43], v[128:143]
    v_add_u32 v230, s28, v230
    s_waitcnt vmcnt(0)
    v_mfma_f32_32x32x16_bf16 v[112:127], v[72:75], v[44:47], v[112:127]
    ds_write_b128 v231, v[204:207]
    v_mfma_f32_32x32x16_bf16 v[128:143], v[76:79], v[44:47], v[128:143]
    v_add_u32 v231, s28, v231
    s_waitcnt lgkmcnt(0)
    s_barrier
    ds_read_b128 v[176:179], v233 offset:0
    ds_read_b128 v[180:183], v234 offset:0
    ds_read_b128 v[184:187], v233 offset:16384
    ds_read_b128 v[188:191], v234 offset:16384
    ds_read_b128 v[192:195], v235 offset:0
    ds_read_b128 v[196:199], v236 offset:0
    ds_read_b128 v[200:203], v235 offset:16384
    ds_read_b128 v[204:207], v236 offset:16384
    ds_write_b128 v224, v[112:115]
    ds_write_b128 v225, v[116:119]
    ds_write_b128 v226, v[120:123]
    ds_write_b128 v227, v[124:127]
    s_waitcnt lgkmcnt(4)
    v_add_f32 v176, v176, v184
    ds_write_b128 v228, v[128:131]
    v_add_f32 v177, v177, v185
    v_add_f32 v178, v178, v186
    v_add_f32 v179, v179, v187
    v_add_f32 v180, v180, v188
    v_add_f32 v181, v181, v189
    v_add_f32 v182, v182, v190
    v_add_f32 v183, v183, v191
    v_add_f32 v192, v192, v200
    ds_write_b128 v229, v[132:135]
    v_add_f32 v193, v193, v201
    v_add_f32 v194, v194, v202
    v_add_f32 v195, v195, v203
    v_add_f32 v196, v196, v204
    v_add_f32 v197, v197, v205
    v_add_f32 v198, v198, v206
    v_add_f32 v199, v199, v207
    v_add_f32 v176, v176, v192
    ds_write_b128 v230, v[136:139]
    v_add_f32 v177, v177, v193
    v_add_f32 v178, v178, v194
    v_add_f32 v179, v179, v195
    v_add_f32 v180, v180, v196
    v_add_f32 v181, v181, v197
    v_add_f32 v182, v182, v198
    v_add_f32 v183, v183, v199
    v_mul_f32 v184, 0xbfb8aa3b, v176
    ds_write_b128 v231, v[140:143]
    v_mul_f32 v185, 0xbfb8aa3b, v177
    v_mul_f32 v186, 0xbfb8aa3b, v178
    v_mul_f32 v187, 0xbfb8aa3b, v179
    v_mul_f32 v188, 0xbfb8aa3b, v180
    v_mul_f32 v189, 0xbfb8aa3b, v181
    v_mul_f32 v190, 0xbfb8aa3b, v182
    v_mul_f32 v191, 0xbfb8aa3b, v183
    v_exp_f32 v184, v184
    v_exp_f32 v185, v185
    v_exp_f32 v186, v186
    v_exp_f32 v187, v187
    v_exp_f32 v188, v188
    v_exp_f32 v189, v189
    v_exp_f32 v190, v190
    v_exp_f32 v191, v191
    v_add_f32 v184, 1.0, v184
    v_add_f32 v185, 1.0, v185
    v_add_f32 v186, 1.0, v186
    v_add_f32 v187, 1.0, v187
    v_add_f32 v188, 1.0, v188
    v_add_f32 v189, 1.0, v189
    v_add_f32 v190, 1.0, v190
    v_add_f32 v191, 1.0, v191
    v_rcp_f32 v184, v184
    v_rcp_f32 v185, v185
    v_rcp_f32 v186, v186
    v_rcp_f32 v187, v187
    v_rcp_f32 v188, v188
    v_rcp_f32 v189, v189
    v_rcp_f32 v190, v190
    v_rcp_f32 v191, v191
    v_mul_f32 v176, v176, v184
    v_mul_f32 v177, v177, v185
    v_mul_f32 v178, v178, v186
    v_mul_f32 v179, v179, v187
    v_mul_f32 v180, v180, v188
    v_mul_f32 v181, v181, v189
    v_mul_f32 v182, v182, v190
    v_mul_f32 v183, v183, v191
    s_waitcnt lgkmcnt(0)
    s_barrier
    ds_read_b128 v[144:147], v233 offset:32768
    ds_read_b128 v[148:151], v234 offset:32768
    ds_read_b128 v[152:155], v233 offset:49152
    ds_read_b128 v[156:159], v234 offset:49152
    ds_read_b128 v[160:163], v237 offset:0
    ds_read_b128 v[164:167], v238 offset:0
    ds_read_b128 v[168:171], v237 offset:16384
    ds_read_b128 v[172:175], v238 offset:16384
    s_waitcnt lgkmcnt(4)
    v_pk_add_f32 v[144:145], v[144:145], v[152:153]
    v_pk_add_f32 v[146:147], v[146:147], v[154:155]
    v_pk_add_f32 v[148:149], v[148:149], v[156:157]
    v_pk_add_f32 v[150:151], v[150:151], v[158:159]
    s_waitcnt lgkmcnt(0)
    v_pk_add_f32 v[160:161], v[160:161], v[168:169]
    v_pk_add_f32 v[162:163], v[162:163], v[170:171]
    v_pk_add_f32 v[164:165], v[164:165], v[172:173]
    v_pk_add_f32 v[166:167], v[166:167], v[174:175]
    v_pk_add_f32 v[144:145], v[144:145], v[160:161]
    v_pk_add_f32 v[146:147], v[146:147], v[162:163]
    v_pk_add_f32 v[148:149], v[148:149], v[164:165]
    v_pk_add_f32 v[150:151], v[150:151], v[166:167]
    v_pk_fma_f32 v[144:145], v[144:145], v[176:177], v[208:209]
    v_pk_fma_f32 v[146:147], v[146:147], v[178:179], v[210:211]
    v_pk_fma_f32 v[148:149], v[148:149], v[180:181], v[212:213]
    v_pk_fma_f32 v[150:151], v[150:151], v[182:183], v[214:215]
    v_cvt_pk_bf16_f32 v96, v144, v145
    v_cvt_pk_bf16_f32 v97, v146, v147
    v_cvt_pk_bf16_f32 v98, v148, v149
    v_cvt_pk_bf16_f32 v99, v150, v151
    buffer_store_dwordx4 v[96:99], v254, s[44:47], 0 offen sc1
L_done:
    s_endpgm
L_pspin:
    s_mov_b32 s63, 20000
L_pchk:
    buffer_load_dword v235, v238, s[24:27], 0 offen sc1
    s_waitcnt vmcnt(0)
    v_cmp_gt_u32 vcc, 4, v235
    s_cbranch_vccz L_pok
    s_sub_u32 s63, s63, 1
    s_cbranch_scc0 L_pchk
    s_branch L_pok
L_qstA:
    s_nop 1
    v_pk_mul_f32 v[32:33], v[32:33], v[224:225]
    v_pk_mul_f32 v[34:35], v[34:35], v[224:225]
    v_pk_mul_f32 v[36:37], v[36:37], v[224:225]
    v_pk_mul_f32 v[38:39], v[38:39], v[224:225]
    v_pk_mul_f32 v[40:41], v[40:41], v[224:225]
    v_pk_mul_f32 v[42:43], v[42:43], v[224:225]
    v_pk_mul_f32 v[44:45], v[44:45], v[224:225]
    v_pk_mul_f32 v[46:47], v[46:47], v[224:225]
    v_cvt_pk_bf16_f32 v32, v32, v33
    v_cvt_pk_bf16_f32 v33, v34, v35
    v_cvt_pk_bf16_f32 v34, v36, v37
    v_cvt_pk_bf16_f32 v35, v38, v39
    v_cvt_pk_bf16_f32 v36, v40, v41
    v_cvt_pk_bf16_f32 v37, v42, v43
    v_cvt_pk_bf16_f32 v38, v44, v45
    v_cvt_pk_bf16_f32 v39, v46, v47
    s_add_u32 s3, s57, 0
    s_add_u32 s30, s57, 8192
    buffer_store_dwordx4 v[32:35], v232, s[20:23], s3 offen sc1
    buffer_store_dwordx4 v[36:39], v232, s[20:23], s30 offen sc1
    v_pk_mul_f32 v[64:65], v[64:65], v[224:225]
    v_pk_mul_f32 v[66:67], v[66:67], v[224:225]
    v_pk_mul_f32 v[68:69], v[68:69], v[224:225]
    v_pk_mul_f32 v[70:71], v[70:71], v[224:225]
    v_pk_mul_f32 v[72:73], v[72:73], v[224:225]
    v_pk_mul_f32 v[74:75], v[74:75], v[224:225]
    v_pk_mul_f32 v[76:77], v[76:77], v[224:225]
    v_pk_mul_f32 v[78:79], v[78:79], v[224:225]
    v_cvt_pk_bf16_f32 v64, v64, v65
    v_cvt_pk_bf16_f32 v65, v66, v67
    v_cvt_pk_bf16_f32 v66, v68, v69
    v_cvt_pk_bf16_f32 v67, v70, v71
    v_cvt_pk_bf16_f32 v68, v72, v73
    v_cvt_pk_bf16_f32 v69, v74, v75
    v_cvt_pk_bf16_f32 v70, v76, v77
    v_cvt_pk_bf16_f32 v71, v78, v79
    s_add_u32 s3, s57, 32768
    s_add_u32 s30, s57, 40960
    buffer_store_dwordx4 v[64:67], v232, s[20:23], s3 offen sc1
    buffer_store_dwordx4 v[68:71], v232, s[20:23], s30 offen sc1
    v_pk_mul_f32 v[48:49], v[48:49], v[226:227]
    v_pk_mul_f32 v[50:51], v[50:51], v[226:227]
    v_pk_mul_f32 v[52:53], v[52:53], v[226:227]
    v_pk_mul_f32 v[54:55], v[54:55], v[226:227]
    v_pk_mul_f32 v[56:57], v[56:57], v[226:227]
    v_pk_mul_f32 v[58:59], v[58:59], v[226:227]
    v_pk_mul_f32 v[60:61], v[60:61], v[226:227]
    v_pk_mul_f32 v[62:63], v[62:63], v[226:227]
    v_cvt_pk_bf16_f32 v48, v48, v49
    v_cvt_pk_bf16_f32 v49, v50, v51
    v_cvt_pk_bf16_f32 v50, v52, v53
    v_cvt_pk_bf16_f32 v51, v54, v55
    v_cvt_pk_bf16_f32 v52, v56, v57
    v_cvt_pk_bf16_f32 v53, v58, v59
    v_cvt_pk_bf16_f32 v54, v60, v61
    v_cvt_pk_bf16_f32 v55, v62, v63
    s_add_u32 s3, s58, 0
    s_add_u32 s30, s58, 8192
    buffer_store_dwordx4 v[48:51], v232, s[20:23], s3 offen sc1
    buffer_store_dwordx4 v[52:55], v232, s[20:23], s30 offen sc1
    v_pk_mul_f32 v[80:81], v[80:81], v[226:227]
    v_pk_mul_f32 v[82:83], v[82:83], v[226:227]
    v_pk_mul_f32 v[84:85], v[84:85], v[226:227]
    v_pk_mul_f32 v[86:87], v[86:87], v[226:227]
    v_pk_mul_f32 v[88:89], v[88:89], v[226:227]
    v_pk_mul_f32 v[90:91], v[90:91], v[226:227]
    v_pk_mul_f32 v[92:93], v[92:93], v[226:227]
    v_pk_mul_f32 v[94:95], v[94:95], v[226:227]
    v_cvt_pk_bf16_f32 v80, v80, v81
    v_cvt_pk_bf16_f32 v81, v82, v83
    v_cvt_pk_bf16_f32 v82, v84, v85
    v_cvt_pk_bf16_f32 v83, v86, v87
    v_cvt_pk_bf16_f32 v84, v88, v89
    v_cvt_pk_bf16_f32 v85, v90, v91
    v_cvt_pk_bf16_f32 v86, v92, v93
    v_cvt_pk_bf16_f32 v87, v94, v95
    s_add_u32 s3, s58, 32768
    s_add_u32 s30, s58, 40960
    buffer_store_dwordx4 v[80:83], v232, s[20:23], s3 offen sc1
    buffer_store_dwordx4 v[84:87], v232, s[20:23], s30 offen sc1
    s_branch L_kvA
L_qstB:
    v_pk_mul_f32 v[32:33], v[32:33], v[224:225]
    v_pk_mul_f32 v[34:35], v[34:35], v[224:225]
    v_pk_mul_f32 v[36:37], v[36:37], v[224:225]
    v_pk_mul_f32 v[38:39], v[38:39], v[224:225]
    v_pk_mul_f32 v[40:41], v[40:41], v[224:225]
    v_pk_mul_f32 v[42:43], v[42:43], v[224:225]
    v_pk_mul_f32 v[44:45], v[44:45], v[224:225]
    v_pk_mul_f32 v[46:47], v[46:47], v[224:225]
    v_cvt_pk_bf16_f32 v32, v32, v33
    v_cvt_pk_bf16_f32 v33, v34, v35
    v_cvt_pk_bf16_f32 v34, v36, v37
    v_cvt_pk_bf16_f32 v35, v38, v39
    v_cvt_pk_bf16_f32 v36, v40, v41
    v_cvt_pk_bf16_f32 v37, v42, v43
    v_cvt_pk_bf16_f32 v38, v44, v45
    v_cvt_pk_bf16_f32 v39, v46, v47
    s_add_u32 s3, s57, 0
    s_add_u32 s30, s57, 8192
    buffer_store_dwordx4 v[32:35], v232, s[20:23], s3 offen sc1
    buffer_store_dwordx4 v[36:39], v232, s[20:23], s30 offen sc1
    v_pk_mul_f32 v[64:65], v[64:65], v[224:225]
    v_pk_mul_f32 v[66:67], v[66:67], v[224:225]
    v_pk_mul_f32 v[68:69], v[68:69], v[224:225]
    v_pk_mul_f32 v[70:71], v[70:71], v[224:225]
    v_pk_mul_f32 v[72:73], v[72:73], v[224:225]
    v_pk_mul_f32 v[74:75], v[74:75], v[224:225]
    v_pk_mul_f32 v[76:77], v[76:77], v[224:225]
    v_pk_mul_f32 v[78:79], v[78:79], v[224:225]
    v_cvt_pk_bf16_f32 v64, v64, v65
    v_cvt_pk_bf16_f32 v65, v66, v67
    v_cvt_pk_bf16_f32 v66, v68, v69
    v_cvt_pk_bf16_f32 v67, v70, v71
    v_cvt_pk_bf16_f32 v68, v72, v73
    v_cvt_pk_bf16_f32 v69, v74, v75
    v_cvt_pk_bf16_f32 v70, v76, v77
    v_cvt_pk_bf16_f32 v71, v78, v79
    s_add_u32 s3, s57, 32768
    s_add_u32 s30, s57, 40960
    buffer_store_dwordx4 v[64:67], v232, s[20:23], s3 offen sc1
    buffer_store_dwordx4 v[68:71], v232, s[20:23], s30 offen sc1
    v_pk_mul_f32 v[48:49], v[48:49], v[226:227]
    v_pk_mul_f32 v[50:51], v[50:51], v[226:227]
    v_pk_mul_f32 v[52:53], v[52:53], v[226:227]
    v_pk_mul_f32 v[54:55], v[54:55], v[226:227]
    v_pk_mul_f32 v[56:57], v[56:57], v[226:227]
    v_pk_mul_f32 v[58:59], v[58:59], v[226:227]
    v_pk_mul_f32 v[60:61], v[60:61], v[226:227]
    v_pk_mul_f32 v[62:63], v[62:63], v[226:227]
    v_cvt_pk_bf16_f32 v48, v48, v49
    v_cvt_pk_bf16_f32 v49, v50, v51
    v_cvt_pk_bf16_f32 v50, v52, v53
    v_cvt_pk_bf16_f32 v51, v54, v55
    v_cvt_pk_bf16_f32 v52, v56, v57
    v_cvt_pk_bf16_f32 v53, v58, v59
    v_cvt_pk_bf16_f32 v54, v60, v61
    v_cvt_pk_bf16_f32 v55, v62, v63
    s_add_u32 s3, s58, 0
    s_add_u32 s30, s58, 8192
    buffer_store_dwordx4 v[48:51], v232, s[20:23], s3 offen sc1
    buffer_store_dwordx4 v[52:55], v232, s[20:23], s30 offen sc1
    v_pk_mul_f32 v[80:81], v[80:81], v[226:227]
    v_pk_mul_f32 v[82:83], v[82:83], v[226:227]
    v_pk_mul_f32 v[84:85], v[84:85], v[226:227]
    v_pk_mul_f32 v[86:87], v[86:87], v[226:227]
    v_pk_mul_f32 v[88:89], v[88:89], v[226:227]
    v_pk_mul_f32 v[90:91], v[90:91], v[226:227]
    v_pk_mul_f32 v[92:93], v[92:93], v[226:227]
    v_pk_mul_f32 v[94:95], v[94:95], v[226:227]
    v_cvt_pk_bf16_f32 v80, v80, v81
    v_cvt_pk_bf16_f32 v81, v82, v83
    v_cvt_pk_bf16_f32 v82, v84, v85
    v_cvt_pk_bf16_f32 v83, v86, v87
    v_cvt_pk_bf16_f32 v84, v88, v89
    v_cvt_pk_bf16_f32 v85, v90, v91
    v_cvt_pk_bf16_f32 v86, v92, v93
    v_cvt_pk_bf16_f32 v87, v94, v95
    s_add_u32 s3, s58, 32768
    s_add_u32 s30, s58, 40960
    buffer_store_dwordx4 v[80:83], v232, s[20:23], s3 offen sc1
    buffer_store_dwordx4 v[84:87], v232, s[20:23], s30 offen sc1
    s_branch L_kvB
L_f0B:
    s_waitcnt vmcnt(0)
    s_mov_b64 exec, 1
    buffer_store_dword v232, off, s[20:23], s64 sc1
    s_mov_b64 exec, -1
    s_branch L_g0B
L_es:
    s_mov_b32 s63, 20000
L_er:
    buffer_load_dword v235, v247, s[20:23], s65 offen sc1
    s_waitcnt vmcnt(0)
    v_cmp_eq_u32 vcc, -1, v235
    s_cbranch_vccz L_ek
    s_sub_u32 s63, s63, 1
    s_cbranch_scc0 L_er
    s_branch L_ek
L_qs:
    s_mov_b32 s63, 20000
L_qr:
    buffer_load_dwordx4 v[228:231], v232, s[20:23], s59 offen sc1
    s_waitcnt vmcnt(0)
    v_max3_u32 v15, v228, v229, v230
    v_max_u32 v15, v15, v231
    v_cmp_eq_u32 vcc, -1, v15
    s_cbranch_vccz L_qk
    s_sub_u32 s63, s63, 1
    s_cbranch_scc0 L_qr
    s_branch L_qk
L_kvs:
    s_mov_b32 s63, 20000
L_kvr:
    s_add_u32 s3, s61, 0
    buffer_load_dwordx4 v[176:179], v237, s[20:23], s3 offen sc1
    s_add_u32 s3, s61, 4096
    buffer_load_dwordx4 v[180:183], v237, s[20:23], s3 offen sc1
    s_add_u32 s3, s61, 8192
    buffer_load_dwordx4 v[184:187], v237, s[20:23], s3 offen sc1
    s_add_u32 s3, s61, 12288
    buffer_load_dwordx4 v[188:191], v237, s[20:23], s3 offen sc1
    s_add_u32 s3, s61, 16384
    buffer_load_dwordx4 v[192:195], v237, s[20:23], s3 offen sc1
    s_add_u32 s3, s61, 20480
    buffer_load_dwordx4 v[196:199], v237, s[20:23], s3 offen sc1
    s_add_u32 s3, s61, 24576
    buffer_load_dwordx4 v[200:203], v237, s[20:23], s3 offen sc1
    s_add_u32 s3, s61, 28672
    buffer_load_dwordx4 v[204:207], v237, s[20:23], s3 offen sc1
    s_waitcnt vmcnt(0)
    v_max3_u32 v10, v176, v177, v178
    v_max3_u32 v11, v179, v180, v181
    v_max3_u32 v10, v10, v182, v183
    v_max3_u32 v11, v11, v184, v185
    v_max3_u32 v10, v10, v186, v187
    v_max3_u32 v11, v11, v188, v189
    v_max3_u32 v10, v10, v190, v191
    v_max3_u32 v11, v11, v192, v193
    v_max3_u32 v10, v10, v194, v195
    v_max3_u32 v11, v11, v196, v197
    v_max3_u32 v10, v10, v198, v199
    v_max3_u32 v11, v11, v200, v201
    v_max3_u32 v10, v10, v202, v203
    v_max3_u32 v11, v11, v204, v205
    v_max3_u32 v10, v10, v206, v207
    v_max_u32 v10, v10, v11
    v_cmp_eq_u32 vcc, -1, v10
    s_cbranch_vccz L_kvk
    s_sub_u32 s63, s63, 1
    s_cbranch_scc0 L_kvr
    s_branch L_kvk
L_ls:
    s_mov_b32 s63, 20000
L_lr:
    buffer_load_dword v235, v247, s[20:23], s65 offen offset:2048 sc1
    s_waitcnt vmcnt(0)
    v_cmp_eq_u32 vcc, -1, v235
    s_cbranch_vccz L_lk
    s_sub_u32 s63, s63, 1
    s_cbranch_scc0 L_lr
    s_branch L_lk
L_os:
    s_mov_b32 s63, 20000
L_or:
    buffer_load_dword v235, v247, s[20:23], s80 offen sc1
    s_waitcnt vmcnt(0)
    v_cmp_eq_u32 vcc, -1, v235
    s_cbranch_vccz L_ok
    s_sub_u32 s63, s63, 1
    s_cbranch_scc0 L_or
    s_branch L_ok
L_end:
.section .rodata,"a"
.p2align 6
.amdhsa_kernel recurrent_scan__linear_kernel_hedgehog__glu_gated_geglu__prompt_kernel
  .amdhsa_next_free_vgpr 256
  .amdhsa_next_free_sgpr 102
  .amdhsa_accum_offset 256
  .amdhsa_group_segment_fixed_size 0
  .amdhsa_kernarg_size 88
  .amdhsa_user_sgpr_count 2
  .amdhsa_user_sgpr_kernarg_segment_ptr 1
  .amdhsa_system_sgpr_workgroup_id_x 1
.end_amdhsa_kernel
```
